```python
import torch

def _softmax(x, axis=-1):
    return torch.softmax(x, dim=axis)
def _gelu(x):
    return torch.nn.functional.gelu(x, approximate="tanh")
def _silu(x):
    return torch.nn.functional.silu(x)
def _sigmoid(x):
    return torch.sigmoid(x)
def _layernorm(x, axis=-1, eps=1e-5):
    m = x.mean(dim=axis, keepdim=True)
    v = x.var(dim=axis, keepdim=True, unbiased=False)
    return (x - m) / torch.sqrt(v + eps)
def _scatter_add(tgt, idx, src, axis=0):
    return tgt.clone().index_add_(axis, idx, src)
def _segment_sum(src, seg, n):
    out = torch.zeros((n,) + src.shape[1:], dtype=src.dtype)
    return out.index_add_(0, seg, src)
def _pad(x, pw):
    flat = tuple(v for pair in reversed(pw) for v in pair)
    return torch.nn.functional.pad(x, flat)

kernel_name = 'gated_mix__ssm_conv_s4__glu_gated_bilinear__prompt'

def setup_inputs():

    _w = (lambda a: (lambda t: t.to(torch.bfloat16) if t.is_floating_point() else t)(torch.as_tensor(a)))
    def _A_setup():
        B, L, D, N = 1, 2048, 640, 128
        A_re = -(lambda _x: torch.exp(torch.as_tensor(_x)))((lambda *s: torch.randn(*s, dtype=torch.bfloat16) * 3.2)(D, N))
        A_im = torch.pi * (lambda *s: torch.randn(*s, dtype=torch.bfloat16) * 0.05)(D, N)
        B_re = (lambda *s: torch.randn(*s, dtype=torch.bfloat16) * 0.1)(D, N)
        B_im = (lambda *s: torch.randn(*s, dtype=torch.bfloat16) * 0.1)(D, N)
        C_re = (lambda *s: torch.randn(*s, dtype=torch.bfloat16) * 0.1)(D, N)
        C_im = (lambda *s: torch.randn(*s, dtype=torch.bfloat16) * 0.1)(D, N)
        log_dt = (lambda *s: torch.randn(*s, dtype=torch.bfloat16) * 0.05)(D) * 0.5 - 4.0
        Dskip = (lambda *s: torch.randn(*s, dtype=torch.bfloat16) * 0.05)(D)
        return {
            "u": _w((lambda *s: torch.randn(*s, dtype=torch.bfloat16) * 0.05)(B, L, D)),
            "A_re": _w(A_re),
            "A_im": _w(A_im),
            "B_re": _w(B_re),
            "B_im": _w(B_im),
            "C_re": _w(C_re),
            "C_im": _w(C_im),
            "log_dt": _w(log_dt),
            "Dskip": _w(Dskip),
        }
    _A_in = _A_setup()

    def _B_setup():
        B, S, D, F = 1, 2048, 640, 1728
        return {
            "x": _w((lambda *s: torch.randn(*s, dtype=torch.bfloat16) * 0.05)(B, S, D)),
            "w_gate": _w((lambda *s: torch.randn(*s, dtype=torch.bfloat16) * 0.8)(D, F) * (D ** -0.5)),
            "w_up": _w((lambda *s: torch.randn(*s, dtype=torch.bfloat16) * 0.8)(D, F) * (D ** -0.5)),
            "w_down": _w((lambda *s: torch.randn(*s, dtype=torch.bfloat16) * 0.8)(F, D) * (F ** -0.5)),
        }
    _B_in = _B_setup()

    return {
        "A_u": _A_in["u"],
        "A_A_re": _A_in["A_re"],
        "A_A_im": _A_in["A_im"],
        "A_B_re": _A_in["B_re"],
        "A_B_im": _A_in["B_im"],
        "A_C_re": _A_in["C_re"],
        "A_C_im": _A_in["C_im"],
        "A_log_dt": _A_in["log_dt"],
        "A_Dskip": _A_in["Dskip"],
        "B_x": _B_in["x"],
        "B_w_gate": _B_in["w_gate"],
        "B_w_up": _B_in["w_up"],
        "B_w_down": _B_in["w_down"],
        "gate_w": _w((lambda *s: torch.randn(*s, dtype=torch.bfloat16) * 0.05)(640) * 16.0),
    }

def reference(A_u, A_A_re, A_A_im, A_B_re, A_B_im, A_C_re, A_C_im, A_log_dt, A_Dskip, B_x, B_w_gate, B_w_up, B_w_down, gate_w):
    def _A_ref(u, A_re, A_im, B_re, B_im, C_re, C_im, log_dt, Dskip):
        Bsz, L, D = u.shape
        dt = torch.exp(log_dt)[:, None]
        A = A_re + 1j * A_im
        Bc = B_re + 1j * B_im
        Cc = C_re + 1j * C_im
        logdA = dt * A
        dB = dt * Bc
        l = (lambda x, dt: x.to(dt))(torch.arange(L), A_re.dtype)
        P = torch.exp(logdA[:, :, None] * l[None, None, :])
        K = torch.einsum("dn,dnl,dn->dl", Cc, P, dB).real
        L2 = 2 * L
        Kp = _pad(K, ((0, 0), (0, L)))
        up = (lambda x, *d: x.permute(*d))(u, 0, 2, 1)
        up = _pad(up, ((0, 0), (0, 0), (0, L)))
        Kf = (lambda x, axes=(-2,-1): torch.fft.rfft2(x.float(), dim=axes))(Kp[:, None, :], axes=(-2, -1))
        Uf = (lambda x, axes=(-2,-1): torch.fft.rfft2(x.float(), dim=axes))(up[:, :, None, :], axes=(-2, -1))
        Yf = Uf * Kf[None, :, :, :]
        y = (lambda x, s, axes=(-2,-1): torch.fft.irfft2(x, s=s, dim=axes).to(torch.bfloat16))(Yf, (1, L2), axes=(-2, -1))[:, :, 0, :L]
        y = (lambda x, *d: x.permute(*d))(y, 0, 2, 1) + u * Dskip[None, None, :]
        return y

    def _B_ref(x, w_gate, w_up, w_down):
        g = torch.einsum("bsd,df->bsf", x, w_gate)
        u = torch.einsum("bsd,df->bsf", x, w_up)
        h = g * u
        return torch.einsum("bsf,fd->bsd", h, w_down)

    x = A_u
    g = _sigmoid((x * gate_w).sum(-1, keepdims=True))
    a = _A_ref(x, A_A_re, A_A_im, A_B_re, A_B_im, A_C_re, A_C_im, A_log_dt, A_Dskip)
    b = _B_ref(x, B_w_gate, B_w_up, B_w_down)
    return g * a + (1 - g) * b
```

```asm
; @launch grid=(256,1,1) block=(512,1,1) lds=163840
.amdgcn_target "amdgcn-amd-amdhsa--gfx950"
.text
.globl gated_mix__ssm_conv_s4__glu_gated_bilinear__prompt_kernel
.p2align 12
.p2align 8
.type gated_mix__ssm_conv_s4__glu_gated_bilinear__prompt_kernel,@function
gated_mix__ssm_conv_s4__glu_gated_bilinear__prompt_kernel:
    s_cmp_ge_u32 s2, 256
    s_cbranch_scc1 L_end
    s_load_dwordx2 s[4:5], s[0:1], 0
    s_load_dwordx16 s[64:79], s[0:1], 72
    s_load_dwordx16 s[32:47], s[0:1], 8
    s_getpc_b64 s[80:81]
L_pc:
    s_lshr_b32 s82, s2, 3
    s_mul_i32 s83, s82, 52
    s_lshr_b32 s83, s83, 8
    s_mul_i32 s83, s83, 5
    s_sub_u32 s82, s82, s83
    s_lshl_b32 s82, s82, 13
    v_lshl_add_u32 v3, v0, 7, s82
    v_cmp_gt_u32 vcc, 64, v0
    v_min_u32 v3, L_end-L_pc, v3
    v_mov_b32 v5, s81
    v_add_co_u32 v4, s[84:85], s80, v3
    s_nop 1
    v_addc_co_u32 v5, s[84:85], 0, v5, s[84:85]
    s_and_saveexec_b64 s[84:85], vcc
    s_cbranch_execz L_ncw
    global_load_dword v63, v[4:5], off
L_ncw:
    s_mov_b64 exec, s[84:85]
    v_lshrrev_b32 v1, 6, v0
    v_and_b32 v2, 63, v0
    v_readfirstlane_b32 s3, v1
    v_lshlrev_b32 v1, 4, v2
    s_and_b32 s80, s2, 7
    s_lshr_b32 s81, s2, 3
    s_and_b32 s82, s80, 1
    s_lshr_b32 s83, s80, 1
    s_lshl_b32 s53, s82, 10
    s_mul_i32 s84, s83, 5
    s_lshr_b32 s85, s81, 3
    s_lshl2_add_u32 s85, s83, s85
    s_xor_b32 s86, s82, 1
    s_lshl4_add_u32 s57, s86, s85
    s_and_b32 s58, s81, 7
    s_and_b32 s56, s3, 3
    s_mov_b32 s54, 1
    s_cmp_lt_u32 s81, 20
    s_cbranch_scc0 L_map_large
    s_lshr_b32 s85, s81, 2
    s_and_b32 s86, s81, 3
    s_cmp_ge_u32 s86, s85
    s_cselect_b32 s87, 1, 0
    s_add_u32 s88, s86, s87
    s_mul_i32 s86, s86, 192
    s_lshl_b32 s87, s87, 8
    s_add_u32 s86, s86, s87
    s_add_u32 s53, s53, s86
    s_mov_b32 s54, 0
    s_mul_i32 s55, s80, 20
    s_add_u32 s55, s55, s81
    s_lshl_b32 s63, s81, 3
    s_add_u32 s63, s63, s80
    s_lshl_b32 s63, s63, 2
    s_add_u32 s63, s63, s56
    s_branch L_map_col
L_map_large:
    s_cmp_lt_u32 s81, 25
    s_cbranch_scc0 L_map_k2
    s_sub_u32 s85, s81, 20
    s_mov_b32 s88, s85
    s_mul_i32 s86, s85, 192
    s_add_u32 s53, s53, s86
L_map_col:
    s_add_u32 s52, s84, s85
    s_add_u32 s59, s85, s88
    s_sub_u32 s60, s85, s88
    s_add_u32 s60, s60, 5
    s_cmp_ge_u32 s60, 5
    s_cselect_b32 s93, 5, 0
    s_sub_u32 s60, s60, s93
    s_mul_i32 s61, s82, 5
    s_add_u32 s61, s61, s88
    s_lshl_b32 s61, s61, 1
    s_lshr_b32 s86, s83, 1
    s_add_u32 s61, s61, s86
    s_lshl_b32 s86, s85, 6
    s_sub_u32 s86, s86, 32
    s_cmp_eq_u32 s83, 0
    s_cselect_b32 s62, s86, -1
    s_branch L_map_done
L_map_k2:
    s_mul_i32 s84, s83, 7
    s_add_u32 s84, s84, s81
    s_sub_u32 s84, s84, 25
    s_lshr_b32 s85, s84, 2
    s_add_u32 s52, s85, 20
    s_and_b32 s84, s84, 3
    s_add_u32 s59, s85, s84
    s_lshl_b32 s84, s84, 8
    s_add_u32 s53, s53, s84
    s_movk_i32 s60, 99
    s_lshl_b32 s62, s85, 5
    s_mov_b32 s61, 0
L_map_done:
    s_cmp_ge_u32 s59, 5
    s_cselect_b32 s93, 5, 0
    s_sub_u32 s59, s59, s93
    s_xor_b32 s84, s82, s83
    s_and_b32 s84, s84, 1
    s_mul_i32 s84, s84, 5
    s_add_u32 s59, s59, s84
    s_waitcnt lgkmcnt(0)
    s_cmp_eq_u32 s54, 1
    s_cbranch_scc1 L_nopar
    s_lshl_b32 s80, s55, 2
    s_add_u32 s80, s80, s56
    s_lshl_b32 s81, s80, 8
    s_lshr_b32 s82, s3, 2
    s_lshl_b32 s82, s82, 7
    s_add_u32 s81, s81, s82
    v_lshlrev_b32 v3, 1, v2
    v_add_u32 v4, s81, v3
    s_lshl_b32 s80, s80, 1
    v_mov_b32 v5, s80
    global_load_ushort v26, v5, s[44:45]
    global_load_ushort v20, v4, s[32:33] nt
    global_load_ushort v21, v4, s[34:35] nt
    global_load_ushort v22, v4, s[36:37] nt
    global_load_ushort v23, v4, s[38:39] nt
    global_load_ushort v24, v4, s[40:41] nt
    global_load_ushort v25, v4, s[42:43] nt
    global_load_ushort v27, v5, s[46:47]
L_nopar:
    s_mov_b32 s6, 2621440
    s_mov_b32 s7, 0x20000
    s_mov_b32 s8, s66
    s_mov_b32 s9, s67
    s_mov_b32 s10, 2211840
    s_mov_b32 s11, 0x20000
    s_mov_b32 s12, s68
    s_mov_b32 s13, s69
    s_mov_b32 s14, 2211840
    s_mov_b32 s15, 0x20000
    s_mov_b32 s16, s78
    s_mov_b32 s17, s79
    s_mov_b32 s18, 33554432
    s_mov_b32 s19, 0x20000
    s_mov_b32 s20, s74
    s_mov_b32 s21, s75
    s_mov_b32 s22, 2621440
    s_mov_b32 s23, 0x20000
    s_mov_b32 s24, s70
    s_mov_b32 s25, s71
    s_mov_b32 s26, 2211840
    s_mov_b32 s27, 0x20000
    s_mov_b32 s28, s76
    s_mov_b32 s29, s77
    s_mov_b32 s30, 256
    s_mov_b32 s31, 0x20000
    s_mov_b32 s48, s72
    s_mov_b32 s49, s73
    s_mov_b32 s50, 1280
    s_mov_b32 s51, 0x20000
    s_cmp_ge_u32 s3, 4
    s_cbranch_scc1 L_helper
    s_cmp_eq_u32 s54, 1
    s_cbranch_scc1 L_comp_large
    s_mul_i32 s84, s63, 6554
    s_lshr_b32 s84, s84, 16
    s_mul_i32 s85, s84, 10
    s_sub_u32 s85, s63, s85
    s_mul_i32 s86, s84, 40960
    s_lshl_b32 s87, s85, 7
    s_add_u32 s86, s86, s87
    s_cmp_lt_u32 s63, 540
    s_cselect_b32 s34, s86, 2146435072
    v_lshrrev_b32 v3, 3, v2
    v_mul_u32_u24 v4, 1280, v3
    v_and_b32 v5, 7, v2
    v_lshl_add_u32 v160, v5, 4, v4
    buffer_load_dwordx4 v[128:131], v160, s[24:27], s34 offen nt
    s_add_u32 s34, s34, 10240
    buffer_load_dwordx4 v[132:135], v160, s[24:27], s34 offen nt
    s_add_u32 s34, s34, 10240
    buffer_load_dwordx4 v[136:139], v160, s[24:27], s34 offen nt
    s_add_u32 s34, s34, 10240
    buffer_load_dwordx4 v[140:143], v160, s[24:27], s34 offen nt
    s_lshl_b32 s86, s85, 8
    s_lshl_b32 s87, s84, 2
    s_add_u32 s86, s86, s87
    s_add_u32 s35, s86, 5120
    s_lshl_b32 s85, s85, 2
    s_mul_i32 s87, s85, 52
    s_lshr_b32 s87, s87, 8
    s_mul_i32 s88, s87, 5
    s_sub_u32 s86, s85, s88
    s_sub_u32 s38, 5, s86
    s_mul_i32 s87, s87, 276480
    s_lshl_b32 s86, s86, 10
    s_add_u32 s86, s86, s87
    s_mul_i32 s84, s84, 5120
    s_add_u32 s86, s86, s84
    s_add_u32 s86, s86, 5505024
    s_cmp_lt_u32 s63, 540
    s_cselect_b32 s35, s35, 2146435072
    s_cselect_b32 s36, s86, 2146435072
    s_add_u32 s37, s36, 271360
    s_cmp_le_u32 s38, 1
    s_cselect_b32 s40, s37, s36
    s_cmp_le_u32 s38, 2
    s_cselect_b32 s41, s37, s36
    s_cmp_le_u32 s38, 3
    s_cselect_b32 s42, s37, s36
    v_bfe_u32 v3, v2, 4, 1
    v_lshlrev_b32 v3, 4, v3
    v_lshrrev_b32 v4, 5, v2
    v_lshlrev_b32 v4, 2, v4
    v_bfe_u32 v5, v2, 2, 2
    v_add3_u32 v3, v3, v4, v5
    v_lshlrev_b32 v3, 7, v3
    v_and_b32 v4, 3, v2
    v_lshl_add_u32 v161, v4, 3, v3
    s_lshr_b32 s70, s3, 1
    s_and_b32 s71, s3, 1
    v_and_b32 v3, 31, v2
    v_lshrrev_b32 v4, 5, v2
    v_lshrrev_b32 v5, 1, v3
    v_and_b32 v5, 7, v5
    v_xor_b32 v5, v5, v4
    v_lshlrev_b32 v5, 4, v5
    s_mul_i32 s80, s70, 12288
    v_lshlrev_b32 v3, 7, v3
    v_add3_u32 v9, v3, v5, s80
    v_xor_b32 v10, 32, v9
    v_xor_b32 v11, 64, v9
    v_xor_b32 v12, 96, v9
    v_lshlrev_b32 v3, 3, v4
    v_bfe_u32 v5, v2, 2, 2
    v_add_u32 v3, v3, v5
    v_lshlrev_b32 v3, 7, v3
    v_bfe_u32 v5, v2, 3, 1
    v_xor_b32 v5, s71, v5
    v_lshlrev_b32 v5, 6, v5
    v_add_u32 v3, v3, v5
    v_bfe_u32 v5, v2, 4, 1
    v_lshlrev_b32 v5, 5, v5
    v_add_u32 v3, v3, v5
    v_and_b32 v5, 3, v2
    v_lshlrev_b32 v5, 3, v5
    s_mov_b32 s80, 24576
    v_add3_u32 v8, v3, v5, s80
    v_mov_b64 v[224:225], 0
    v_mov_b64 v[226:227], 0
    v_mov_b64 v[228:229], 0
    v_mov_b64 v[230:231], 0
    v_mov_b64 v[232:233], 0
    v_mov_b64 v[234:235], 0
    v_mov_b64 v[236:237], 0
    v_mov_b64 v[238:239], 0
    v_mov_b64 v[240:241], 0
    v_mov_b64 v[242:243], 0
    v_mov_b64 v[244:245], 0
    v_mov_b64 v[246:247], 0
    v_mov_b64 v[248:249], 0
    v_mov_b64 v[250:251], 0
    v_mov_b64 v[252:253], 0
    v_mov_b64 v[254:255], 0
    s_mov_b32 s72, 0
    s_mov_b32 s73, 1
    s_mov_b32 s74, 40960
    s_mov_b32 s75, 40960
    s_add_u32 s85, s59, s60
    s_cmp_ge_u32 s85, 10
    s_cselect_b32 s86, 10, 0
    s_sub_u32 s85, s85, s86
    s_lshl_b32 s85, s85, 2
    s_add_u32 s85, s85, s56
    s_lshl_b32 s85, s85, 7
    s_lshl_b32 s86, s61, 2
    s_add_u32 s85, s85, s86
    s_add_u32 s44, s85, 0
    s_add_u32 s45, s60, 2
    v_bfe_u32 v3, v2, 4, 1
    v_lshlrev_b32 v3, 10, v3
    v_lshrrev_b32 v4, 5, v2
    v_lshlrev_b32 v4, 9, v4
    v_and_b32 v5, 15, v2
    v_lshlrev_b32 v5, 4, v5
    v_add3_u32 v16, v3, v4, v5
    s_lshl_b32 s80, s52, 1
    s_add_u32 s80, s80, s71
    s_lshl_b32 s81, s80, 12
    s_add_u32 s81, s81, 7733248
    s_mul_i32 s82, s70, 3
    s_lshr_b32 s83, s53, 5
    s_add_u32 s82, s82, s83
    s_lshl_b32 s84, s82, 8
    s_lshl_b32 s80, s80, 2
    s_add_u32 s84, s84, s80
    s_add_u32 s61, s84, 18432
    s_lshr_b32 s83, s82, 1
    s_mul_i32 s83, s83, 221184
    s_and_b32 s84, s82, 1
    s_lshl_b32 s84, s84, 11
    s_add_u32 s83, s83, s84
    s_add_u32 s76, s83, s81
    s_add_u32 s82, s82, 1
    s_lshr_b32 s83, s82, 1
    s_mul_i32 s83, s83, 221184
    s_and_b32 s84, s82, 1
    s_lshl_b32 s84, s84, 11
    s_add_u32 s83, s83, s84
    s_add_u32 s77, s83, s81
    s_add_u32 s82, s82, 1
    s_lshr_b32 s83, s82, 1
    s_mul_i32 s83, s83, 221184
    s_and_b32 s84, s82, 1
    s_lshl_b32 s84, s84, 11
    s_add_u32 s83, s83, s84
    s_add_u32 s78, s83, s81
    s_add_u32 s82, s82, 1
    s_mul_i32 s69, s57, 221184
    s_lshl_b32 s80, s70, 12
    s_add_u32 s69, s69, s80
    s_lshl_b32 s80, s71, 11
    s_add_u32 s69, s69, s80
    s_add_u32 s69, s69, 7733248
    s_and_b32 s80, s57, 15
    s_mul_i32 s80, s80, 11
    s_lshr_b32 s80, s80, 5
    s_min_u32 s80, s80, 4
    s_add_u32 s81, s80, 1
    s_cmp_ge_u32 s81, 5
    s_cselect_b32 s93, 5, 0
    s_sub_u32 s81, s81, s93
    s_mul_i32 s81, s81, 8192
    s_add_u32 s64, s81, s69
    s_add_u32 s81, s80, 2
    s_cmp_ge_u32 s81, 5
    s_cselect_b32 s93, 5, 0
    s_sub_u32 s81, s81, s93
    s_mul_i32 s81, s81, 8192
    s_add_u32 s65, s81, s69
    s_add_u32 s81, s80, 3
    s_cmp_ge_u32 s81, 5
    s_cselect_b32 s93, 5, 0
    s_sub_u32 s81, s81, s93
    s_mul_i32 s81, s81, 8192
    s_add_u32 s66, s81, s69
    s_add_u32 s81, s80, 4
    s_cmp_ge_u32 s81, 5
    s_cselect_b32 s93, 5, 0
    s_sub_u32 s81, s81, s93
    s_mul_i32 s81, s81, 8192
    s_add_u32 s67, s81, s69
    s_add_u32 s81, s80, 5
    s_cmp_ge_u32 s81, 5
    s_cselect_b32 s93, 5, 0
    s_sub_u32 s81, s81, s93
    s_mul_i32 s81, s81, 8192
    s_add_u32 s68, s81, s69
    s_add_u32 s80, s80, 1
    v_lshrrev_b32 v3, 2, v2
    v_add_u32 v3, s80, v3
    v_subrev_u32 v4, 5, v3
    v_cmp_gt_u32 vcc, 5, v3
    s_nop 1
    v_cndmask_b32 v3, v4, v3, vcc
    v_and_b32 v4, 3, v2
    v_mad_u32_u24 v3, v4, 5, v3
    v_min_u32 v4, 26, v2
    v_cmp_gt_u32 vcc, 20, v2
    s_nop 1
    v_cndmask_b32 v3, v4, v3, vcc
    v_lshlrev_b32 v3, 3, v3
    s_lshl_b32 s80, s57, 1
    s_add_u32 s80, s80, s71
    s_lshl_b32 s80, s80, 8
    s_lshl_b32 s81, s70, 2
    s_add_u32 s80, s80, s81
    s_add_u32 s80, s80, 18432
    v_add_u32 v13, s80, v3
    s_mul_i32 s80, s3, 4160
    s_add_u32 s80, s80, 97112
    s_mul_i32 s81, s3, 4608
    s_add_u32 s81, s81, 61472
    v_and_b32 v3, 3, v2
    v_mul_u32_u24 v3, 16704, v3
    v_bfe_u32 v4, v2, 2, 2
    v_lshlrev_b32 v4, 3, v4
    v_sub_u32 v3, v3, v4
    v_lshrrev_b32 v4, 4, v2
    v_lshlrev_b32 v5, 4, v4
    v_add3_u32 v14, v3, v5, s80
    v_and_b32 v3, 15, v2
    v_lshlrev_b32 v3, 5, v3
    v_add3_u32 v15, v3, v5, s81
    v_bfe_u32 v4, v2, 4, 1
    v_lshlrev_b32 v4, 9, v4
    v_lshrrev_b32 v5, 5, v2
    v_lshlrev_b32 v5, 4, v5
    v_add3_u32 v17, v3, v4, v5
    s_lshr_b32 s82, s3, 2
    s_mul_i32 s82, s82, 40960
    s_mul_i32 s81, s56, 8704
    s_sub_u32 s81, s81, s82
    s_add_u32 s89, s81, 122880
    s_mov_b32 m0, s89
    v_and_b32 v4, 31, v2
    v_mul_u32_u24 v4, 272, v4
    v_lshrrev_b32 v5, 5, v2
    v_lshlrev_b32 v5, 4, v5
    v_add3_u32 v58, v4, v5, s89
    s_mov_b32 s83, 0x3fb8aa3b
    s_mov_b32 s84, 0x3fb8aa3b
    s_mov_b32 s85, 0x3e22f983
    s_mov_b32 s86, 0x4138aa3b
    s_mov_b32 s87, 0x3fa2f983
    s_mov_b32 s90, 0x43b8aa3b
    s_mov_b32 s91, 0x4222f983
    s_waitcnt vmcnt(4)
    v_lshlrev_b32 v26, 16, v26
    v_lshlrev_b32 v20, 16, v20
    v_mul_f32 v28, s83, v26
    v_lshlrev_b32 v21, 16, v21
    v_fma_f32 v29, v26, s83, -v28
    v_exp_f32 v30, v28
    v_fmac_f32 v29, 0x32a57060, v26
    v_lshlrev_b32 v22, 16, v22
    v_mul_f32 v29, 0x3f317218, v29
    v_lshlrev_b32 v23, 16, v23
    v_fmac_f32 v30, v30, v29
    v_lshlrev_b32 v24, 16, v24
    v_cvt_pk_bf16_f32 v30, v30, v30
    v_lshlrev_b32 v25, 16, v25
    v_lshlrev_b32 v32, 16, v30
    v_mov_b32 v34, 0x3f80
    v_pk_mul_f32 v[20:21], v[20:21], v[32:33] op_sel_hi:[1,0]
    v_pk_mul_f32 v[22:23], v[22:23], v[32:33] op_sel_hi:[1,0]
    v_pk_mul_f32 v[36:37], v[20:21], s[86:87]
    v_pk_mul_f32 v[38:39], v[20:21], s[90:91]
    v_fract_f32 v35, v37
    v_exp_f32 v40, v36
    v_cos_f32 v42, v35
    v_fract_f32 v44, v39
    v_exp_f32 v46, v38
    v_sin_f32 v43, v35
    v_cos_f32 v48, v44
    v_pk_mul_f32 v[50:51], v[24:25], v[22:23] op_sel:[0,0] op_sel_hi:[0,1]
    v_pk_mul_f32 v[52:53], v[42:43], v[40:41] op_sel_hi:[1,0]
    v_sin_f32 v49, v44
    v_pk_fma_f32 v[50:51], v[24:25], v[22:23], v[50:51] op_sel:[1,1,0] op_sel_hi:[1,0,1] neg_lo:[0,1,0]
    v_pk_mul_f32 v[54:55], v[20:21], s[84:85]
    v_cvt_pk_bf16_f32 v35, v50, v51
    v_pk_mul_f32 v[56:57], v[48:49], v[46:47] op_sel_hi:[1,0]
    ds_write_addtid_b32 v35 offset:0
    v_pk_mul_f32 v[96:97], v[50:51], v[56:57] op_sel:[0,0] op_sel_hi:[0,1]
    v_fract_f32 v35, v55
    v_pk_fma_f32 v[96:97], v[50:51], v[56:57], v[96:97] op_sel:[1,1,0] op_sel_hi:[1,0,1] neg_lo:[0,1,0]
    v_cos_f32 v98, v35
    v_cvt_pk_bf16_f32 v100, v96, v97
    v_pk_mul_f32 v[102:103], v[96:97], v[56:57] op_sel:[0,0] op_sel_hi:[0,1]
    ds_write_addtid_b32 v100 offset:1088
    v_pk_fma_f32 v[102:103], v[96:97], v[56:57], v[102:103] op_sel:[1,1,0] op_sel_hi:[1,0,1] neg_lo:[0,1,0]
    v_exp_f32 v104, v54
    v_cvt_pk_bf16_f32 v101, v102, v103
    ds_write_addtid_b32 v100 offset:1360
    v_pk_mul_f32 v[106:107], v[102:103], v[56:57] op_sel:[0,0] op_sel_hi:[0,1]
    v_sin_f32 v99, v35
    v_pk_fma_f32 v[106:107], v[102:103], v[56:57], v[106:107] op_sel:[1,1,0] op_sel_hi:[1,0,1] neg_lo:[0,1,0]
    ds_write_addtid_b32 v101 offset:4352
    v_cvt_pk_bf16_f32 v35, v106, v107
    v_pk_mul_f32 v[108:109], v[106:107], v[56:57] op_sel:[0,0] op_sel_hi:[0,1]
    v_pk_mul_f32 v[110:111], v[98:99], v[104:105] op_sel_hi:[1,0]
    ds_write_addtid_b32 v35 offset:5440
    v_pk_fma_f32 v[108:109], v[106:107], v[56:57], v[108:109] op_sel:[1,1,0] op_sel_hi:[1,0,1] neg_lo:[0,1,0]
    v_pk_mul_f32 v[112:113], v[110:111], v[110:111] op_sel:[0,0] op_sel_hi:[0,1]
    v_cvt_pk_bf16_f32 v35, v108, v109
    v_pk_mul_f32 v[114:115], v[50:51], v[110:111] op_sel:[0,0] op_sel_hi:[0,1]
    ds_write_addtid_b32 v35 offset:5168
    v_pk_mul_f32 v[116:117], v[108:109], v[56:57] op_sel:[0,0] op_sel_hi:[0,1]
    v_pk_fma_f32 v[112:113], v[110:111], v[110:111], v[112:113] op_sel:[1,1,0] op_sel_hi:[1,0,1] neg_lo:[0,1,0]
    v_pk_fma_f32 v[114:115], v[50:51], v[110:111], v[114:115] op_sel:[1,1,0] op_sel_hi:[1,0,1] neg_lo:[0,1,0]
    v_pk_fma_f32 v[116:117], v[108:109], v[56:57], v[116:117] op_sel:[1,1,0] op_sel_hi:[1,0,1] neg_lo:[0,1,0]
    v_cvt_pk_bf16_f32 v35, v114, v115
    v_cvt_pk_bf16_f32 v118, v116, v117
    ds_write_addtid_b32 v35 offset:272
    v_pk_mul_f32 v[120:121], v[112:113], v[112:113] op_sel:[0,0] op_sel_hi:[0,1]
    v_pk_mul_f32 v[122:123], v[50:51], v[112:113] op_sel:[0,0] op_sel_hi:[0,1]
    v_pk_mul_f32 v[124:125], v[114:115], v[112:113] op_sel:[0,0] op_sel_hi:[0,1]
    ds_write_addtid_b32 v118 offset:6256
    v_pk_mul_f32 v[126:127], v[116:117], v[56:57] op_sel:[0,0] op_sel_hi:[0,1]
    v_pk_fma_f32 v[120:121], v[112:113], v[112:113], v[120:121] op_sel:[1,1,0] op_sel_hi:[1,0,1] neg_lo:[0,1,0]
    v_pk_fma_f32 v[122:123], v[50:51], v[112:113], v[122:123] op_sel:[1,1,0] op_sel_hi:[1,0,1] neg_lo:[0,1,0]
    v_pk_fma_f32 v[124:125], v[114:115], v[112:113], v[124:125] op_sel:[1,1,0] op_sel_hi:[1,0,1] neg_lo:[0,1,0]
    v_cvt_pk_bf16_f32 v35, v122, v123
    v_cvt_pk_bf16_f32 v28, v124, v125
    ds_write_addtid_b32 v35 offset:544
    v_pk_fma_f32 v[126:127], v[116:117], v[56:57], v[126:127] op_sel:[1,1,0] op_sel_hi:[1,0,1] neg_lo:[0,1,0]
    v_pk_mul_f32 v[30:31], v[122:123], v[112:113] op_sel:[0,0] op_sel_hi:[0,1]
    v_cvt_pk_bf16_f32 v29, v126, v127
    ds_write_addtid_b32 v28 offset:816
    v_pk_mul_f32 v[32:33], v[124:125], v[112:113] op_sel:[0,0] op_sel_hi:[0,1]
    v_pk_mul_f32 v[36:37], v[96:97], v[120:121] op_sel:[0,0] op_sel_hi:[0,1]
    v_pk_mul_f32 v[38:39], v[126:127], v[56:57] op_sel:[0,0] op_sel_hi:[0,1]
    ds_write_addtid_b32 v29 offset:6800
    v_pk_fma_f32 v[30:31], v[122:123], v[112:113], v[30:31] op_sel:[1,1,0] op_sel_hi:[1,0,1] neg_lo:[0,1,0]
    v_pk_fma_f32 v[32:33], v[124:125], v[112:113], v[32:33] op_sel:[1,1,0] op_sel_hi:[1,0,1] neg_lo:[0,1,0]
    v_cvt_pk_bf16_f32 v35, v30, v31
    v_cvt_pk_bf16_f32 v42, v32, v33
    ds_write_addtid_b32 v35 offset:2176
    v_pk_fma_f32 v[36:37], v[96:97], v[120:121], v[36:37] op_sel:[1,1,0] op_sel_hi:[1,0,1] neg_lo:[0,1,0]
    v_pk_fma_f32 v[38:39], v[126:127], v[56:57], v[38:39] op_sel:[1,1,0] op_sel_hi:[1,0,1] neg_lo:[0,1,0]
    v_cvt_pk_bf16_f32 v43, v36, v37
    ds_write_addtid_b32 v42 offset:2448
    v_cvt_pk_bf16_f32 v35, v38, v39
    v_pk_mul_f32 v[40:41], v[30:31], v[112:113] op_sel:[0,0] op_sel_hi:[0,1]
    v_pk_mul_f32 v[44:45], v[32:33], v[112:113] op_sel:[0,0] op_sel_hi:[0,1]
    ds_write_addtid_b32 v43 offset:1904
    v_pk_mul_f32 v[48:49], v[96:97], v[112:113] op_sel:[0,0] op_sel_hi:[0,1]
    v_pk_mul_f32 v[46:47], v[36:37], v[112:113] op_sel:[0,0] op_sel_hi:[0,1]
    v_pk_mul_f32 v[54:55], v[96:97], v[52:53] op_sel:[0,0] op_sel_hi:[0,1]
    ds_write_addtid_b32 v43 offset:3264
    v_pk_mul_f32 v[100:101], v[102:103], v[120:121] op_sel:[0,0] op_sel_hi:[0,1]
    v_pk_mul_f32 v[98:99], v[102:103], v[52:53] op_sel:[0,0] op_sel_hi:[0,1]
    v_pk_mul_f32 v[104:105], v[106:107], v[120:121] op_sel:[0,0] op_sel_hi:[0,1]
    ds_write_addtid_b32 v43 offset:3536
    v_pk_mul_f32 v[110:111], v[106:107], v[52:53] op_sel:[0,0] op_sel_hi:[0,1]
    v_pk_mul_f32 v[118:119], v[108:109], v[52:53] op_sel:[0,0] op_sel_hi:[0,1]
    v_pk_mul_f32 v[50:51], v[116:117], v[52:53] op_sel:[0,0] op_sel_hi:[0,1]
    ds_write_addtid_b32 v35 offset:7888
    v_pk_mul_f32 v[114:115], v[126:127], v[52:53] op_sel:[0,0] op_sel_hi:[0,1]
    v_pk_mul_f32 v[28:29], v[38:39], v[52:53] op_sel:[0,0] op_sel_hi:[0,1]
    v_pk_fma_f32 v[40:41], v[30:31], v[112:113], v[40:41] op_sel:[1,1,0] op_sel_hi:[1,0,1] neg_lo:[0,1,0]
    v_pk_fma_f32 v[44:45], v[32:33], v[112:113], v[44:45] op_sel:[1,1,0] op_sel_hi:[1,0,1] neg_lo:[0,1,0]
    v_cvt_pk_bf16_f32 v35, v40, v41
    v_cvt_pk_bf16_f32 v122, v44, v45
    ds_write_addtid_b32 v35 offset:2720
    v_pk_fma_f32 v[48:49], v[96:97], v[112:113], v[48:49] op_sel:[1,1,0] op_sel_hi:[1,0,1] neg_lo:[0,1,0]
    v_pk_fma_f32 v[46:47], v[36:37], v[112:113], v[46:47] op_sel:[1,1,0] op_sel_hi:[1,0,1] neg_lo:[0,1,0]
    v_cvt_pk_bf16_f32 v123, v48, v49
    ds_write_addtid_b32 v122 offset:2992
    v_cvt_pk_bf16_f32 v35, v46, v47
    v_pk_fma_f32 v[54:55], v[96:97], v[52:53], v[54:55] op_sel:[1,1,0] op_sel_hi:[1,0,1] neg_lo:[0,1,0]
    v_pk_fma_f32 v[100:101], v[102:103], v[120:121], v[100:101] op_sel:[1,1,0] op_sel_hi:[1,0,1] neg_lo:[0,1,0]
    ds_write_addtid_b32 v123 offset:1632
    v_cvt_pk_bf16_f32 v124, v54, v55
    v_cvt_pk_bf16_f32 v125, v100, v101
    v_pk_fma_f32 v[98:99], v[102:103], v[52:53], v[98:99] op_sel:[1,1,0] op_sel_hi:[1,0,1] neg_lo:[0,1,0]
    ds_write_addtid_b32 v35 offset:3808
    v_cvt_pk_bf16_f32 v35, v98, v99
    v_pk_fma_f32 v[104:105], v[106:107], v[120:121], v[104:105] op_sel:[1,1,0] op_sel_hi:[1,0,1] neg_lo:[0,1,0]
    v_pk_fma_f32 v[110:111], v[106:107], v[52:53], v[110:111] op_sel:[1,1,0] op_sel_hi:[1,0,1] neg_lo:[0,1,0]
    ds_write_addtid_b32 v124 offset:4080
    v_cvt_pk_bf16_f32 v124, v104, v105
    v_cvt_pk_bf16_f32 v56, v110, v111
    v_pk_fma_f32 v[118:119], v[108:109], v[52:53], v[118:119] op_sel:[1,1,0] op_sel_hi:[1,0,1] neg_lo:[0,1,0]
    ds_write_addtid_b32 v125 offset:4624
    v_cvt_pk_bf16_f32 v57, v118, v119
    v_pk_fma_f32 v[50:51], v[116:117], v[52:53], v[50:51] op_sel:[1,1,0] op_sel_hi:[1,0,1] neg_lo:[0,1,0]
    v_pk_fma_f32 v[114:115], v[126:127], v[52:53], v[114:115] op_sel:[1,1,0] op_sel_hi:[1,0,1] neg_lo:[0,1,0]
    ds_write_addtid_b32 v35 offset:4896
    v_cvt_pk_bf16_f32 v125, v50, v51
    v_cvt_pk_bf16_f32 v35, v114, v115
    v_pk_fma_f32 v[28:29], v[38:39], v[52:53], v[28:29] op_sel:[1,1,0] op_sel_hi:[1,0,1] neg_lo:[0,1,0]
    ds_write_addtid_b32 v124 offset:5712
    v_cvt_pk_bf16_f32 v124, v28, v29
    v_pk_mul_f32 v[42:43], v[52:53], 1.0 op_sel_hi:[1,0] neg_hi:[1,0]
    ds_write_addtid_b32 v56 offset:5984
    v_cvt_pk_bf16_f32 v56, v42, v43
    v_pk_mul_f32 v[30:31], v[42:43], v[42:43] op_sel:[0,0] op_sel_hi:[0,1]
    ds_write_addtid_b32 v57 offset:6528
    v_pk_fma_f32 v[30:31], v[42:43], v[42:43], v[30:31] op_sel:[1,1,0] op_sel_hi:[1,0,1] neg_lo:[0,1,0]
    ds_write_addtid_b32 v125 offset:7616
    v_cvt_pk_bf16_f32 v57, v30, v31
    v_pk_mul_f32 v[32:33], v[42:43], v[30:31] op_sel:[0,0] op_sel_hi:[0,1]
    v_pk_mul_f32 v[40:41], v[30:31], v[30:31] op_sel:[0,0] op_sel_hi:[0,1]
    ds_write_addtid_b32 v35 offset:7072
    v_pk_fma_f32 v[32:33], v[42:43], v[30:31], v[32:33] op_sel:[1,1,0] op_sel_hi:[1,0,1] neg_lo:[0,1,0]
    v_pk_fma_f32 v[40:41], v[30:31], v[30:31], v[40:41] op_sel:[1,1,0] op_sel_hi:[1,0,1] neg_lo:[0,1,0]
    v_cvt_pk_bf16_f32 v125, v32, v33
    ds_write_addtid_b32 v124 offset:8160
    v_cvt_pk_bf16_f32 v35, v40, v41
    v_pk_mul_f32 v[44:45], v[32:33], v[30:31] op_sel:[0,0] op_sel_hi:[0,1]
    v_pk_mul_f32 v[36:37], v[40:41], v[30:31] op_sel:[0,0] op_sel_hi:[0,1]
    ds_read_b128 v[64:67], v58 offset:0
    v_pk_fma_f32 v[44:45], v[32:33], v[30:31], v[44:45] op_sel:[1,1,0] op_sel_hi:[1,0,1] neg_lo:[0,1,0]
    v_pk_fma_f32 v[36:37], v[40:41], v[30:31], v[36:37] op_sel:[1,1,0] op_sel_hi:[1,0,1] neg_lo:[0,1,0]
    v_cvt_pk_bf16_f32 v124, v44, v45
    ds_read_b128 v[68:71], v58 offset:32
    v_cvt_pk_bf16_f32 v112, v36, v37
    v_pk_mul_f32 v[48:49], v[44:45], v[30:31] op_sel:[0,0] op_sel_hi:[0,1]
    v_pk_mul_f32 v[46:47], v[36:37], v[30:31] op_sel:[0,0] op_sel_hi:[0,1]
    ds_read_b128 v[72:75], v58 offset:64
    v_pk_fma_f32 v[48:49], v[44:45], v[30:31], v[48:49] op_sel:[1,1,0] op_sel_hi:[1,0,1] neg_lo:[0,1,0]
    v_pk_fma_f32 v[46:47], v[36:37], v[30:31], v[46:47] op_sel:[1,1,0] op_sel_hi:[1,0,1] neg_lo:[0,1,0]
    v_cvt_pk_bf16_f32 v113, v48, v49
    ds_read_b128 v[76:79], v58 offset:96
    v_cvt_pk_bf16_f32 v96, v46, v47
    v_pk_mul_f32 v[122:123], v[48:49], v[30:31] op_sel:[0,0] op_sel_hi:[0,1]
    v_pk_mul_f32 v[54:55], v[46:47], v[30:31] op_sel:[0,0] op_sel_hi:[0,1]
    ds_read_b128 v[80:83], v58 offset:128
    v_pk_fma_f32 v[122:123], v[48:49], v[30:31], v[122:123] op_sel:[1,1,0] op_sel_hi:[1,0,1] neg_lo:[0,1,0]
    v_pk_fma_f32 v[54:55], v[46:47], v[30:31], v[54:55] op_sel:[1,1,0] op_sel_hi:[1,0,1] neg_lo:[0,1,0]
    v_cvt_pk_bf16_f32 v97, v122, v123
    ds_read_b128 v[84:87], v58 offset:160
    v_cvt_pk_bf16_f32 v100, v54, v55
    v_pk_mul_f32 v[102:103], v[122:123], v[30:31] op_sel:[0,0] op_sel_hi:[0,1]
    v_pk_mul_f32 v[98:99], v[54:55], v[30:31] op_sel:[0,0] op_sel_hi:[0,1]
    ds_read_b128 v[88:91], v58 offset:192
    v_pk_fma_f32 v[102:103], v[122:123], v[30:31], v[102:103] op_sel:[1,1,0] op_sel_hi:[1,0,1] neg_lo:[0,1,0]
    v_pk_fma_f32 v[98:99], v[54:55], v[30:31], v[98:99] op_sel:[1,1,0] op_sel_hi:[1,0,1] neg_lo:[0,1,0]
    v_cvt_pk_bf16_f32 v101, v102, v103
    ds_read_b128 v[92:95], v58 offset:224
    v_cvt_pk_bf16_f32 v120, v98, v99
    v_pk_mul_f32 v[106:107], v[102:103], v[30:31] op_sel:[0,0] op_sel_hi:[0,1]
    v_pk_mul_f32 v[104:105], v[98:99], v[30:31] op_sel:[0,0] op_sel_hi:[0,1]
    ds_write_addtid_b32 v34
    v_pk_fma_f32 v[106:107], v[102:103], v[30:31], v[106:107] op_sel:[1,1,0] op_sel_hi:[1,0,1] neg_lo:[0,1,0]
    v_pk_fma_f32 v[104:105], v[98:99], v[30:31], v[104:105] op_sel:[1,1,0] op_sel_hi:[1,0,1] neg_lo:[0,1,0]
    v_cvt_pk_bf16_f32 v121, v106, v107
    ds_write_addtid_b32 v56 offset:272
    v_cvt_pk_bf16_f32 v34, v104, v105
    v_pk_mul_f32 v[110:111], v[106:107], v[30:31] op_sel:[0,0] op_sel_hi:[0,1]
    v_pk_mul_f32 v[108:109], v[104:105], v[30:31] op_sel:[0,0] op_sel_hi:[0,1]
    ds_write_addtid_b32 v57 offset:544
    v_pk_fma_f32 v[110:111], v[106:107], v[30:31], v[110:111] op_sel:[1,1,0] op_sel_hi:[1,0,1] neg_lo:[0,1,0]
    v_pk_fma_f32 v[108:109], v[104:105], v[30:31], v[108:109] op_sel:[1,1,0] op_sel_hi:[1,0,1] neg_lo:[0,1,0]
    v_cvt_pk_bf16_f32 v118, v110, v111
    ds_write_addtid_b32 v125 offset:816
    v_cvt_pk_bf16_f32 v119, v108, v109
    v_pk_mul_f32 v[116:117], v[110:111], v[30:31] op_sel:[0,0] op_sel_hi:[0,1]
    v_pk_mul_f32 v[126:127], v[108:109], v[30:31] op_sel:[0,0] op_sel_hi:[0,1]
    ds_write_addtid_b32 v35 offset:1088
    v_pk_fma_f32 v[116:117], v[110:111], v[30:31], v[116:117] op_sel:[1,1,0] op_sel_hi:[1,0,1] neg_lo:[0,1,0]
    v_pk_fma_f32 v[126:127], v[108:109], v[30:31], v[126:127] op_sel:[1,1,0] op_sel_hi:[1,0,1] neg_lo:[0,1,0]
    v_cvt_pk_bf16_f32 v125, v116, v117
    ds_write_addtid_b32 v124 offset:1360
    v_cvt_pk_bf16_f32 v35, v126, v127
    v_pk_mul_f32 v[50:51], v[116:117], v[30:31] op_sel:[0,0] op_sel_hi:[0,1]
    v_pk_mul_f32 v[114:115], v[126:127], v[30:31] op_sel:[0,0] op_sel_hi:[0,1]
    ds_write_addtid_b32 v112 offset:1632
    v_pk_fma_f32 v[50:51], v[116:117], v[30:31], v[50:51] op_sel:[1,1,0] op_sel_hi:[1,0,1] neg_lo:[0,1,0]
    v_pk_fma_f32 v[114:115], v[126:127], v[30:31], v[114:115] op_sel:[1,1,0] op_sel_hi:[1,0,1] neg_lo:[0,1,0]
    v_cvt_pk_bf16_f32 v124, v50, v51
    ds_write_addtid_b32 v113 offset:1904
    v_cvt_pk_bf16_f32 v38, v114, v115
    v_pk_mul_f32 v[28:29], v[50:51], v[30:31] op_sel:[0,0] op_sel_hi:[0,1]
    v_pk_mul_f32 v[52:53], v[114:115], v[30:31] op_sel:[0,0] op_sel_hi:[0,1]
    ds_write_addtid_b32 v96 offset:2176
    v_pk_fma_f32 v[28:29], v[50:51], v[30:31], v[28:29] op_sel:[1,1,0] op_sel_hi:[1,0,1] neg_lo:[0,1,0]
    v_pk_fma_f32 v[52:53], v[114:115], v[30:31], v[52:53] op_sel:[1,1,0] op_sel_hi:[1,0,1] neg_lo:[0,1,0]
    v_cvt_pk_bf16_f32 v39, v28, v29
    ds_write_addtid_b32 v97 offset:2448
    v_cvt_pk_bf16_f32 v42, v52, v53
    v_pk_mul_f32 v[32:33], v[28:29], v[30:31] op_sel:[0,0] op_sel_hi:[0,1]
    v_pk_mul_f32 v[40:41], v[52:53], v[30:31] op_sel:[0,0] op_sel_hi:[0,1]
    ds_write_addtid_b32 v100 offset:2720
    v_pk_fma_f32 v[32:33], v[28:29], v[30:31], v[32:33] op_sel:[1,1,0] op_sel_hi:[1,0,1] neg_lo:[0,1,0]
    v_pk_fma_f32 v[40:41], v[52:53], v[30:31], v[40:41] op_sel:[1,1,0] op_sel_hi:[1,0,1] neg_lo:[0,1,0]
    v_cvt_pk_bf16_f32 v43, v32, v33
    ds_write_addtid_b32 v101 offset:2992
    v_cvt_pk_bf16_f32 v44, v40, v41
    v_pk_mul_f32 v[36:37], v[32:33], v[30:31] op_sel:[0,0] op_sel_hi:[0,1]
    v_pk_mul_f32 v[48:49], v[40:41], v[30:31] op_sel:[0,0] op_sel_hi:[0,1]
    ds_write_addtid_b32 v120 offset:3264
    v_pk_fma_f32 v[36:37], v[32:33], v[30:31], v[36:37] op_sel:[1,1,0] op_sel_hi:[1,0,1] neg_lo:[0,1,0]
    v_pk_fma_f32 v[48:49], v[40:41], v[30:31], v[48:49] op_sel:[1,1,0] op_sel_hi:[1,0,1] neg_lo:[0,1,0]
    v_cvt_pk_bf16_f32 v45, v36, v37
    ds_write_addtid_b32 v121 offset:3536
    v_cvt_pk_bf16_f32 v46, v48, v49
    v_pk_mul_f32 v[122:123], v[36:37], v[30:31] op_sel:[0,0] op_sel_hi:[0,1]
    v_pk_mul_f32 v[54:55], v[48:49], v[30:31] op_sel:[0,0] op_sel_hi:[0,1]
    ds_write_addtid_b32 v34 offset:3808
    v_pk_fma_f32 v[122:123], v[36:37], v[30:31], v[122:123] op_sel:[1,1,0] op_sel_hi:[1,0,1] neg_lo:[0,1,0]
    v_pk_fma_f32 v[54:55], v[48:49], v[30:31], v[54:55] op_sel:[1,1,0] op_sel_hi:[1,0,1] neg_lo:[0,1,0]
    v_cvt_pk_bf16_f32 v47, v122, v123
    ds_write_addtid_b32 v118 offset:4080
    v_cvt_pk_bf16_f32 v34, v54, v55
    v_pk_mul_f32 v[102:103], v[122:123], v[30:31] op_sel:[0,0] op_sel_hi:[0,1]
    v_pk_mul_f32 v[98:99], v[54:55], v[30:31] op_sel:[0,0] op_sel_hi:[0,1]
    ds_write_addtid_b32 v119 offset:4352
    v_pk_fma_f32 v[102:103], v[122:123], v[30:31], v[102:103] op_sel:[1,1,0] op_sel_hi:[1,0,1] neg_lo:[0,1,0]
    v_pk_fma_f32 v[98:99], v[54:55], v[30:31], v[98:99] op_sel:[1,1,0] op_sel_hi:[1,0,1] neg_lo:[0,1,0]
    v_cvt_pk_bf16_f32 v56, v102, v103
    ds_write_addtid_b32 v125 offset:4624
    v_cvt_pk_bf16_f32 v57, v98, v99
    v_pk_mul_f32 v[106:107], v[102:103], v[30:31] op_sel:[0,0] op_sel_hi:[0,1]
    ds_write_addtid_b32 v35 offset:4896
    v_pk_fma_f32 v[106:107], v[102:103], v[30:31], v[106:107] op_sel:[1,1,0] op_sel_hi:[1,0,1] neg_lo:[0,1,0]
    ds_write_addtid_b32 v124 offset:5168
    v_cvt_pk_bf16_f32 v35, v106, v107
    ds_write_addtid_b32 v38 offset:5440
    ds_write_addtid_b32 v39 offset:5712
    ds_write_addtid_b32 v42 offset:5984
    ds_write_addtid_b32 v43 offset:6256
    ds_write_addtid_b32 v44 offset:6528
    ds_write_addtid_b32 v45 offset:6800
    ds_write_addtid_b32 v46 offset:7072
    ds_write_addtid_b32 v47 offset:7344
    ds_write_addtid_b32 v34 offset:7616
    ds_write_addtid_b32 v56 offset:7888
    ds_write_addtid_b32 v57 offset:8160
    ds_write_addtid_b32 v35 offset:8432
    ds_read_b128 v[96:99], v58 offset:0
    ds_read_b128 v[100:103], v58 offset:32
    ds_read_b128 v[104:107], v58 offset:64
    ds_read_b128 v[108:111], v58 offset:96
    ds_read_b128 v[112:115], v58 offset:128
    ds_read_b128 v[116:119], v58 offset:160
    ds_read_b128 v[120:123], v58 offset:192
    ds_read_b128 v[124:127], v58 offset:224
    s_waitcnt lgkmcnt(7)
    v_mfma_f32_32x32x16_bf16 v[48:63], v[64:67], v[96:99], 0
    v_add_u32 v160, s89, v1
    v_add_u32 v161, s89, v161
    s_waitcnt vmcnt(0)
    ds_write_b128 v160, v[128:131] offset:0
    s_waitcnt lgkmcnt(7)
    v_mfma_f32_32x32x16_bf16 v[48:63], v[68:71], v[100:103], v[48:63]
    ds_write_b128 v160, v[132:135] offset:1024
    s_waitcnt lgkmcnt(7)
    v_mfma_f32_32x32x16_bf16 v[48:63], v[72:75], v[104:107], v[48:63]
    ds_write_b128 v160, v[136:139] offset:2048
    s_waitcnt lgkmcnt(7)
    v_mfma_f32_32x32x16_bf16 v[48:63], v[76:79], v[108:111], v[48:63]
    ds_write_b128 v160, v[140:143] offset:3072
    s_waitcnt lgkmcnt(7)
    v_mfma_f32_32x32x16_bf16 v[48:63], v[80:83], v[112:115], v[48:63]
    ds_read_b64_tr_b16 v[32:33], v161 offset:0
    ds_read_b64_tr_b16 v[34:35], v161 offset:1024
    s_waitcnt lgkmcnt(8)
    v_mfma_f32_32x32x16_bf16 v[48:63], v[84:87], v[116:119], v[48:63]
    ds_read_b64_tr_b16 v[36:37], v161 offset:32
    ds_read_b64_tr_b16 v[38:39], v161 offset:1056
    s_waitcnt lgkmcnt(9)
    v_mfma_f32_32x32x16_bf16 v[48:63], v[88:91], v[120:123], v[48:63]
    ds_read_b64_tr_b16 v[40:41], v161 offset:64
    ds_read_b64_tr_b16 v[42:43], v161 offset:1088
    s_waitcnt lgkmcnt(10)
    v_mfma_f32_32x32x16_bf16 v[48:63], v[92:95], v[124:127], v[48:63]
    ds_read_b64_tr_b16 v[44:45], v161 offset:96
    ds_read_b64_tr_b16 v[46:47], v161 offset:1120
    v_add_u32 v3, s89, v1
    s_nop 8
    ds_write_b128 v3, v[48:51] offset:0
    ds_write_b128 v3, v[52:55] offset:1024
    ds_write_b128 v3, v[56:59] offset:2048
    ds_write_b128 v3, v[60:63] offset:3072
    s_waitcnt lgkmcnt(10)
    buffer_store_dwordx4 v[32:35], v1, s[16:19], s36 offen offset:0 sc1
    s_waitcnt lgkmcnt(8)
    buffer_store_dwordx4 v[36:39], v1, s[16:19], s40 offen offset:1024 sc1
    s_waitcnt lgkmcnt(6)
    buffer_store_dwordx4 v[40:43], v1, s[16:19], s41 offen offset:2048 sc1
    s_waitcnt lgkmcnt(4)
    buffer_store_dwordx4 v[44:47], v1, s[16:19], s42 offen offset:3072 sc1
    s_waitcnt lgkmcnt(0)
    s_setprio 1
    s_barrier
    ds_read_b64_tr_b16 v[64:65], v8 offset:0
    ds_read_b64_tr_b16 v[66:67], v8 offset:512
    ds_read_b128 v[72:75], v9
    ds_read_b64_tr_b16 v[68:69], v8 offset:8192
    ds_read_b64_tr_b16 v[70:71], v8 offset:8704
    ds_read_b128 v[76:79], v9 offset:4096
    ds_read_b128 v[80:83], v9 offset:8192
    s_waitcnt lgkmcnt(0)
    v_mfma_f32_32x32x16_bf16 v[128:143], v[64:67], v[72:75], 0
    ds_read_b64_tr_b16 v[88:89], v8 offset:2048
    ds_read_b64_tr_b16 v[90:91], v8 offset:2560
    v_mfma_f32_32x32x16_bf16 v[144:159], v[68:71], v[72:75], 0
    ds_read_b128 v[96:99], v10
    ds_read_b64_tr_b16 v[92:93], v8 offset:10240
    v_mfma_f32_32x32x16_bf16 v[160:175], v[64:67], v[76:79], 0
    ds_read_b64_tr_b16 v[94:95], v8 offset:10752
    ds_read_b128 v[100:103], v10 offset:4096
    v_mfma_f32_32x32x16_bf16 v[176:191], v[68:71], v[76:79], 0
    ds_read_b128 v[104:107], v10 offset:8192
    v_mfma_f32_32x32x16_bf16 v[192:207], v[64:67], v[80:83], 0
    v_mfma_f32_32x32x16_bf16 v[208:223], v[68:71], v[80:83], 0
    s_branch L_g1b_s
L_g1_s:
    s_cmp_eq_u32 s72, 2
    s_cbranch_scc1 L_f2
L_f2r:
    s_cmp_eq_u32 s72, s45
    s_cbranch_scc1 L_f1_s
L_f1r_s:
    s_add_u32 s73, s73, 1
    s_cmp_eq_u32 s73, 3
    s_cselect_b32 s75, 4294885376, s74
    s_cselect_b32 s73, 0, s73
    s_waitcnt lgkmcnt(0)
    v_mfma_f32_32x32x16_bf16 v[128:143], v[64:67], v[72:75], v[128:143]
    ds_read_b64_tr_b16 v[88:89], v8 offset:2048
    ds_read_b64_tr_b16 v[90:91], v8 offset:2560
    v_mfma_f32_32x32x16_bf16 v[144:159], v[68:71], v[72:75], v[144:159]
    ds_read_b128 v[96:99], v10
    ds_read_b64_tr_b16 v[92:93], v8 offset:10240
    v_mfma_f32_32x32x16_bf16 v[160:175], v[64:67], v[76:79], v[160:175]
    ds_read_b64_tr_b16 v[94:95], v8 offset:10752
    ds_read_b128 v[100:103], v10 offset:4096
    v_mfma_f32_32x32x16_bf16 v[176:191], v[68:71], v[76:79], v[176:191]
    ds_read_b128 v[104:107], v10 offset:8192
    v_mfma_f32_32x32x16_bf16 v[192:207], v[64:67], v[80:83], v[192:207]
    v_mfma_f32_32x32x16_bf16 v[208:223], v[68:71], v[80:83], v[208:223]
L_g1b_s:
    s_waitcnt lgkmcnt(0)
    v_mfma_f32_32x32x16_bf16 v[128:143], v[88:91], v[96:99], v[128:143]
    ds_read_b64_tr_b16 v[64:65], v8 offset:4096
    ds_read_b64_tr_b16 v[66:67], v8 offset:4608
    v_mfma_f32_32x32x16_bf16 v[144:159], v[92:95], v[96:99], v[144:159]
    ds_read_b128 v[72:75], v11
    ds_read_b64_tr_b16 v[68:69], v8 offset:12288
    v_mfma_f32_32x32x16_bf16 v[160:175], v[88:91], v[100:103], v[160:175]
    ds_read_b64_tr_b16 v[70:71], v8 offset:12800
    ds_read_b128 v[76:79], v11 offset:4096
    v_mfma_f32_32x32x16_bf16 v[176:191], v[92:95], v[100:103], v[176:191]
    ds_read_b128 v[80:83], v11 offset:8192
    v_mfma_f32_32x32x16_bf16 v[192:207], v[88:91], v[104:107], v[192:207]
    v_mfma_f32_32x32x16_bf16 v[208:223], v[92:95], v[104:107], v[208:223]
    s_waitcnt lgkmcnt(0)
    v_mfma_f32_32x32x16_bf16 v[128:143], v[64:67], v[72:75], v[128:143]
    ds_read_b64_tr_b16 v[88:89], v8 offset:6144
    ds_read_b64_tr_b16 v[90:91], v8 offset:6656
    v_mfma_f32_32x32x16_bf16 v[144:159], v[68:71], v[72:75], v[144:159]
    ds_read_b128 v[96:99], v12
    ds_read_b64_tr_b16 v[92:93], v8 offset:14336
    v_mfma_f32_32x32x16_bf16 v[160:175], v[64:67], v[76:79], v[160:175]
    ds_read_b64_tr_b16 v[94:95], v8 offset:14848
    ds_read_b128 v[100:103], v12 offset:4096
    v_mfma_f32_32x32x16_bf16 v[176:191], v[68:71], v[76:79], v[176:191]
    ds_read_b128 v[104:107], v12 offset:8192
    v_add_u32 v8, s75, v8
    v_mfma_f32_32x32x16_bf16 v[192:207], v[64:67], v[80:83], v[192:207]
    v_add_u32 v9, s75, v9
    v_add_u32 v10, s75, v10
    v_mfma_f32_32x32x16_bf16 v[208:223], v[68:71], v[80:83], v[208:223]
    v_add_u32 v11, s75, v11
    v_add_u32 v12, s75, v12
    s_cmp_eq_u32 s72, 9
    s_waitcnt lgkmcnt(0)
    s_cbranch_scc1 L_g1_nbs
    s_barrier
L_g1_nbs:
    v_mfma_f32_32x32x16_bf16 v[128:143], v[88:91], v[96:99], v[128:143]
    ds_read_b64_tr_b16 v[64:65], v8 offset:0
    ds_read_b64_tr_b16 v[66:67], v8 offset:512
    v_mfma_f32_32x32x16_bf16 v[144:159], v[92:95], v[96:99], v[144:159]
    ds_read_b128 v[72:75], v9
    ds_read_b64_tr_b16 v[68:69], v8 offset:8192
    v_mfma_f32_32x32x16_bf16 v[160:175], v[88:91], v[100:103], v[160:175]
    ds_read_b64_tr_b16 v[70:71], v8 offset:8704
    ds_read_b128 v[76:79], v9 offset:4096
    v_mfma_f32_32x32x16_bf16 v[176:191], v[92:95], v[100:103], v[176:191]
    ds_read_b128 v[80:83], v9 offset:8192
    s_add_u32 s72, s72, 1
    v_mfma_f32_32x32x16_bf16 v[192:207], v[88:91], v[104:107], v[192:207]
    s_cmp_lt_u32 s72, 10
    v_mfma_f32_32x32x16_bf16 v[208:223], v[92:95], v[104:107], v[208:223]
    s_cbranch_scc1 L_g1_s
    v_pk_mul_f32 v[128:129], v[128:129], v[144:145]
    v_pk_mul_f32 v[130:131], v[130:131], v[146:147]
    v_pk_mul_f32 v[132:133], v[132:133], v[148:149]
    v_pk_mul_f32 v[134:135], v[134:135], v[150:151]
    v_pk_mul_f32 v[136:137], v[136:137], v[152:153]
    v_pk_mul_f32 v[138:139], v[138:139], v[154:155]
    v_pk_mul_f32 v[140:141], v[140:141], v[156:157]
    v_pk_mul_f32 v[142:143], v[142:143], v[158:159]
    v_cvt_pk_bf16_f32 v24, v128, v129
    v_cvt_pk_bf16_f32 v25, v130, v131
    v_cvt_pk_bf16_f32 v26, v132, v133
    v_cvt_pk_bf16_f32 v27, v134, v135
    v_cvt_pk_bf16_f32 v28, v136, v137
    v_cvt_pk_bf16_f32 v29, v138, v139
    v_cvt_pk_bf16_f32 v30, v140, v141
    v_cvt_pk_bf16_f32 v31, v142, v143
    buffer_store_dwordx4 v[24:27], v16, s[16:19], s76 offen offset:0 sc1
    buffer_store_dwordx4 v[28:31], v16, s[16:19], s76 offen offset:256 sc1
    v_pk_mul_f32 v[160:161], v[160:161], v[176:177]
    v_pk_mul_f32 v[162:163], v[162:163], v[178:179]
    v_pk_mul_f32 v[164:165], v[164:165], v[180:181]
    v_pk_mul_f32 v[166:167], v[166:167], v[182:183]
    v_pk_mul_f32 v[168:169], v[168:169], v[184:185]
    v_pk_mul_f32 v[170:171], v[170:171], v[186:187]
    v_pk_mul_f32 v[172:173], v[172:173], v[188:189]
    v_pk_mul_f32 v[174:175], v[174:175], v[190:191]
    v_cvt_pk_bf16_f32 v32, v160, v161
    v_cvt_pk_bf16_f32 v33, v162, v163
    v_cvt_pk_bf16_f32 v34, v164, v165
    v_cvt_pk_bf16_f32 v35, v166, v167
    v_cvt_pk_bf16_f32 v36, v168, v169
    v_cvt_pk_bf16_f32 v37, v170, v171
    v_cvt_pk_bf16_f32 v38, v172, v173
    v_cvt_pk_bf16_f32 v39, v174, v175
    buffer_store_dwordx4 v[32:35], v16, s[16:19], s77 offen offset:0 sc1
    buffer_store_dwordx4 v[36:39], v16, s[16:19], s77 offen offset:256 sc1
    v_pk_mul_f32 v[192:193], v[192:193], v[208:209]
    v_pk_mul_f32 v[194:195], v[194:195], v[210:211]
    v_pk_mul_f32 v[196:197], v[196:197], v[212:213]
    v_pk_mul_f32 v[198:199], v[198:199], v[214:215]
    v_pk_mul_f32 v[200:201], v[200:201], v[216:217]
    v_pk_mul_f32 v[202:203], v[202:203], v[218:219]
    v_pk_mul_f32 v[204:205], v[204:205], v[220:221]
    v_pk_mul_f32 v[206:207], v[206:207], v[222:223]
    v_cvt_pk_bf16_f32 v40, v192, v193
    v_cvt_pk_bf16_f32 v41, v194, v195
    v_cvt_pk_bf16_f32 v42, v196, v197
    v_cvt_pk_bf16_f32 v43, v198, v199
    v_cvt_pk_bf16_f32 v44, v200, v201
    v_cvt_pk_bf16_f32 v45, v202, v203
    v_cvt_pk_bf16_f32 v46, v204, v205
    v_cvt_pk_bf16_f32 v47, v206, v207
    buffer_store_dwordx4 v[40:43], v16, s[16:19], s78 offen offset:0 sc1
    buffer_store_dwordx4 v[44:47], v16, s[16:19], s78 offen offset:256 sc1
    s_lshl_b32 s80, s70, 10
    v_add_u32 v10, s80, v1
    v_xor_b32 v11, 1024, v10
    s_lshl_b32 s82, s55, 2
    s_add_u32 s82, s82, s3
    s_lshl_b32 s79, s82, 2
    s_add_u32 s79, s79, 7680
    s_mul_i32 s82, s82, 4352
    s_add_u32 s97, s82, 2686976
    v_mov_b32 v12, v17
    s_waitcnt lgkmcnt(0)
    s_barrier
    ds_read_b64 v[64:65], v14 offset:4032
    ds_read_b64 v[66:67], v14 offset:4040
    ds_read_b128 v[96:99], v15 offset:448
    ds_read_b64 v[68:69], v14 offset:3520
    ds_read_b64 v[70:71], v14 offset:3528
    ds_read_b128 v[100:103], v15 offset:960
    ds_read_b64 v[72:73], v14 offset:3008
    ds_read_b64 v[74:75], v14 offset:3016
    ds_read_b128 v[104:107], v15 offset:1472
    ds_read_b64 v[76:77], v14 offset:2496
    ds_read_b64 v[78:79], v14 offset:2504
    ds_read_b128 v[108:111], v15 offset:1984
    ds_read_b64 v[80:81], v14 offset:1984
    ds_read_b64 v[82:83], v14 offset:1992
    ds_read_b128 v[112:115], v15 offset:2496
    ds_read_b64 v[84:85], v14 offset:1472
    ds_read_b64 v[86:87], v14 offset:1480
    ds_read_b128 v[116:119], v15 offset:3008
    ds_read_b64 v[88:89], v14 offset:960
    ds_read_b64 v[90:91], v14 offset:968
    ds_read_b128 v[120:123], v15 offset:3520
    ds_read_b64 v[92:93], v14 offset:448
    ds_read_b64 v[94:95], v14 offset:456
    ds_read_b128 v[124:127], v15 offset:4032
    s_waitcnt lgkmcnt(0)
    v_mfma_f32_16x16x32_bf16 v[224:227], v[64:67], v[96:99], v[224:227]
    ds_read_b64 v[128:129], v14 offset:3968
    v_mfma_f32_16x16x32_bf16 v[228:231], v[64:67], v[100:103], v[228:231]
    ds_read_b64 v[130:131], v14 offset:3976
    v_mfma_f32_16x16x32_bf16 v[228:231], v[68:71], v[96:99], v[228:231]
    ds_read_b128 v[160:163], v15 offset:384
    v_mfma_f32_16x16x32_bf16 v[232:235], v[64:67], v[104:107], v[232:235]
    ds_read_b64 v[132:133], v14 offset:3456
    v_mfma_f32_16x16x32_bf16 v[232:235], v[68:71], v[100:103], v[232:235]
    ds_read_b64 v[134:135], v14 offset:3464
    v_mfma_f32_16x16x32_bf16 v[232:235], v[72:75], v[96:99], v[232:235]
    ds_read_b128 v[164:167], v15 offset:896
    v_mfma_f32_16x16x32_bf16 v[236:239], v[64:67], v[108:111], v[236:239]
    ds_read_b64 v[136:137], v14 offset:2944
    v_mfma_f32_16x16x32_bf16 v[236:239], v[68:71], v[104:107], v[236:239]
    ds_read_b64 v[138:139], v14 offset:2952
    v_mfma_f32_16x16x32_bf16 v[236:239], v[72:75], v[100:103], v[236:239]
    ds_read_b128 v[168:171], v15 offset:1408
    v_mfma_f32_16x16x32_bf16 v[236:239], v[76:79], v[96:99], v[236:239]
    ds_read_b64 v[140:141], v14 offset:2432
    v_mfma_f32_16x16x32_bf16 v[240:243], v[64:67], v[112:115], v[240:243]
    ds_read_b64 v[142:143], v14 offset:2440
    v_mfma_f32_16x16x32_bf16 v[240:243], v[68:71], v[108:111], v[240:243]
    ds_read_b128 v[172:175], v15 offset:1920
    v_mfma_f32_16x16x32_bf16 v[240:243], v[72:75], v[104:107], v[240:243]
    ds_read_b64 v[144:145], v14 offset:1920
    v_mfma_f32_16x16x32_bf16 v[240:243], v[76:79], v[100:103], v[240:243]
    ds_read_b64 v[146:147], v14 offset:1928
    v_mfma_f32_16x16x32_bf16 v[240:243], v[80:83], v[96:99], v[240:243]
    ds_read_b128 v[176:179], v15 offset:2432
    v_mfma_f32_16x16x32_bf16 v[244:247], v[64:67], v[116:119], v[244:247]
    ds_read_b64 v[148:149], v14 offset:1408
    v_mfma_f32_16x16x32_bf16 v[244:247], v[68:71], v[112:115], v[244:247]
    ds_read_b64 v[150:151], v14 offset:1416
    v_mfma_f32_16x16x32_bf16 v[244:247], v[72:75], v[108:111], v[244:247]
    ds_read_b128 v[180:183], v15 offset:2944
    v_mfma_f32_16x16x32_bf16 v[244:247], v[76:79], v[104:107], v[244:247]
    ds_read_b64 v[152:153], v14 offset:896
    v_mfma_f32_16x16x32_bf16 v[244:247], v[80:83], v[100:103], v[244:247]
    ds_read_b64 v[154:155], v14 offset:904
    v_mfma_f32_16x16x32_bf16 v[244:247], v[84:87], v[96:99], v[244:247]
    ds_read_b128 v[184:187], v15 offset:3456
    v_mfma_f32_16x16x32_bf16 v[248:251], v[64:67], v[120:123], v[248:251]
    ds_read_b64 v[156:157], v14 offset:384
    v_mfma_f32_16x16x32_bf16 v[248:251], v[68:71], v[116:119], v[248:251]
    ds_read_b64 v[158:159], v14 offset:392
    v_mfma_f32_16x16x32_bf16 v[248:251], v[72:75], v[112:115], v[248:251]
    ds_read_b128 v[188:191], v15 offset:3968
    v_mfma_f32_16x16x32_bf16 v[248:251], v[76:79], v[108:111], v[248:251]
    v_mfma_f32_16x16x32_bf16 v[248:251], v[80:83], v[104:107], v[248:251]
    v_mfma_f32_16x16x32_bf16 v[248:251], v[84:87], v[100:103], v[248:251]
    v_mfma_f32_16x16x32_bf16 v[248:251], v[88:91], v[96:99], v[248:251]
    v_mfma_f32_16x16x32_bf16 v[252:255], v[64:67], v[124:127], v[252:255]
    v_mfma_f32_16x16x32_bf16 v[252:255], v[68:71], v[120:123], v[252:255]
    v_mfma_f32_16x16x32_bf16 v[252:255], v[72:75], v[116:119], v[252:255]
    v_mfma_f32_16x16x32_bf16 v[252:255], v[76:79], v[112:115], v[252:255]
    v_mfma_f32_16x16x32_bf16 v[252:255], v[80:83], v[108:111], v[252:255]
    v_mfma_f32_16x16x32_bf16 v[252:255], v[84:87], v[104:107], v[252:255]
    v_mfma_f32_16x16x32_bf16 v[252:255], v[88:91], v[100:103], v[252:255]
    v_mfma_f32_16x16x32_bf16 v[252:255], v[92:95], v[96:99], v[252:255]
    s_waitcnt lgkmcnt(0)
    v_mfma_f32_16x16x32_bf16 v[224:227], v[128:131], v[160:163], v[224:227]
    ds_read_b64 v[64:65], v14 offset:3904
    v_mfma_f32_16x16x32_bf16 v[228:231], v[128:131], v[164:167], v[228:231]
    ds_read_b64 v[66:67], v14 offset:3912
    v_mfma_f32_16x16x32_bf16 v[228:231], v[132:135], v[160:163], v[228:231]
    ds_read_b128 v[96:99], v15 offset:320
    v_mfma_f32_16x16x32_bf16 v[232:235], v[128:131], v[168:171], v[232:235]
    ds_read_b64 v[68:69], v14 offset:3392
    v_mfma_f32_16x16x32_bf16 v[232:235], v[132:135], v[164:167], v[232:235]
    ds_read_b64 v[70:71], v14 offset:3400
    v_mfma_f32_16x16x32_bf16 v[232:235], v[136:139], v[160:163], v[232:235]
    ds_read_b128 v[100:103], v15 offset:832
    v_mfma_f32_16x16x32_bf16 v[236:239], v[128:131], v[172:175], v[236:239]
    ds_read_b64 v[72:73], v14 offset:2880
    v_mfma_f32_16x16x32_bf16 v[236:239], v[132:135], v[168:171], v[236:239]
    ds_read_b64 v[74:75], v14 offset:2888
    v_mfma_f32_16x16x32_bf16 v[236:239], v[136:139], v[164:167], v[236:239]
    ds_read_b128 v[104:107], v15 offset:1344
    v_mfma_f32_16x16x32_bf16 v[236:239], v[140:143], v[160:163], v[236:239]
    ds_read_b64 v[76:77], v14 offset:2368
    v_mfma_f32_16x16x32_bf16 v[240:243], v[128:131], v[176:179], v[240:243]
    ds_read_b64 v[78:79], v14 offset:2376
    v_mfma_f32_16x16x32_bf16 v[240:243], v[132:135], v[172:175], v[240:243]
    ds_read_b128 v[108:111], v15 offset:1856
    v_mfma_f32_16x16x32_bf16 v[240:243], v[136:139], v[168:171], v[240:243]
    ds_read_b64 v[80:81], v14 offset:1856
    v_mfma_f32_16x16x32_bf16 v[240:243], v[140:143], v[164:167], v[240:243]
    ds_read_b64 v[82:83], v14 offset:1864
    v_mfma_f32_16x16x32_bf16 v[240:243], v[144:147], v[160:163], v[240:243]
    ds_read_b128 v[112:115], v15 offset:2368
    v_mfma_f32_16x16x32_bf16 v[244:247], v[128:131], v[180:183], v[244:247]
    ds_read_b64 v[84:85], v14 offset:1344
    v_mfma_f32_16x16x32_bf16 v[244:247], v[132:135], v[176:179], v[244:247]
    ds_read_b64 v[86:87], v14 offset:1352
    v_mfma_f32_16x16x32_bf16 v[244:247], v[136:139], v[172:175], v[244:247]
    ds_read_b128 v[116:119], v15 offset:2880
    v_mfma_f32_16x16x32_bf16 v[244:247], v[140:143], v[168:171], v[244:247]
    ds_read_b64 v[88:89], v14 offset:832
    v_mfma_f32_16x16x32_bf16 v[244:247], v[144:147], v[164:167], v[244:247]
    ds_read_b64 v[90:91], v14 offset:840
    v_mfma_f32_16x16x32_bf16 v[244:247], v[148:151], v[160:163], v[244:247]
    ds_read_b128 v[120:123], v15 offset:3392
    v_mfma_f32_16x16x32_bf16 v[248:251], v[128:131], v[184:187], v[248:251]
    ds_read_b64 v[92:93], v14 offset:320
    v_mfma_f32_16x16x32_bf16 v[248:251], v[132:135], v[180:183], v[248:251]
    ds_read_b64 v[94:95], v14 offset:328
    v_mfma_f32_16x16x32_bf16 v[248:251], v[136:139], v[176:179], v[248:251]
    ds_read_b128 v[124:127], v15 offset:3904
    v_mfma_f32_16x16x32_bf16 v[248:251], v[140:143], v[172:175], v[248:251]
    v_mfma_f32_16x16x32_bf16 v[248:251], v[144:147], v[168:171], v[248:251]
    v_mfma_f32_16x16x32_bf16 v[248:251], v[148:151], v[164:167], v[248:251]
    v_mfma_f32_16x16x32_bf16 v[248:251], v[152:155], v[160:163], v[248:251]
    v_mfma_f32_16x16x32_bf16 v[252:255], v[128:131], v[188:191], v[252:255]
    v_mfma_f32_16x16x32_bf16 v[252:255], v[132:135], v[184:187], v[252:255]
    v_mfma_f32_16x16x32_bf16 v[252:255], v[136:139], v[180:183], v[252:255]
    v_mfma_f32_16x16x32_bf16 v[252:255], v[140:143], v[176:179], v[252:255]
    v_mfma_f32_16x16x32_bf16 v[252:255], v[144:147], v[172:175], v[252:255]
    v_mfma_f32_16x16x32_bf16 v[252:255], v[148:151], v[168:171], v[252:255]
    v_mfma_f32_16x16x32_bf16 v[252:255], v[152:155], v[164:167], v[252:255]
    v_mfma_f32_16x16x32_bf16 v[252:255], v[156:159], v[160:163], v[252:255]
    s_waitcnt vmcnt(0)
    v_lshlrev_b32 v18, 8, v2
    v_mov_b32 v19, 1
    s_mov_b64 exec, 7
    buffer_store_dword v19, v18, s[16:19], s61 offen sc1
    s_mov_b64 exec, -1
    s_waitcnt lgkmcnt(0)
    v_mfma_f32_16x16x32_bf16 v[224:227], v[64:67], v[96:99], v[224:227]
    ds_read_b64 v[128:129], v14 offset:3840
    v_mfma_f32_16x16x32_bf16 v[228:231], v[64:67], v[100:103], v[228:231]
    ds_read_b64 v[130:131], v14 offset:3848
    v_mfma_f32_16x16x32_bf16 v[228:231], v[68:71], v[96:99], v[228:231]
    ds_read_b128 v[160:163], v15 offset:256
    v_mfma_f32_16x16x32_bf16 v[232:235], v[64:67], v[104:107], v[232:235]
    ds_read_b64 v[132:133], v14 offset:3328
    v_mfma_f32_16x16x32_bf16 v[232:235], v[68:71], v[100:103], v[232:235]
    ds_read_b64 v[134:135], v14 offset:3336
    v_mfma_f32_16x16x32_bf16 v[232:235], v[72:75], v[96:99], v[232:235]
    ds_read_b128 v[164:167], v15 offset:768
    v_mfma_f32_16x16x32_bf16 v[236:239], v[64:67], v[108:111], v[236:239]
    ds_read_b64 v[136:137], v14 offset:2816
    v_mfma_f32_16x16x32_bf16 v[236:239], v[68:71], v[104:107], v[236:239]
    ds_read_b64 v[138:139], v14 offset:2824
    v_mfma_f32_16x16x32_bf16 v[236:239], v[72:75], v[100:103], v[236:239]
    ds_read_b128 v[168:171], v15 offset:1280
    v_mfma_f32_16x16x32_bf16 v[236:239], v[76:79], v[96:99], v[236:239]
    ds_read_b64 v[140:141], v14 offset:2304
    v_mfma_f32_16x16x32_bf16 v[240:243], v[64:67], v[112:115], v[240:243]
    ds_read_b64 v[142:143], v14 offset:2312
    v_mfma_f32_16x16x32_bf16 v[240:243], v[68:71], v[108:111], v[240:243]
    ds_read_b128 v[172:175], v15 offset:1792
    v_mfma_f32_16x16x32_bf16 v[240:243], v[72:75], v[104:107], v[240:243]
    ds_read_b64 v[144:145], v14 offset:1792
    v_mfma_f32_16x16x32_bf16 v[240:243], v[76:79], v[100:103], v[240:243]
    ds_read_b64 v[146:147], v14 offset:1800
    v_mfma_f32_16x16x32_bf16 v[240:243], v[80:83], v[96:99], v[240:243]
    ds_read_b128 v[176:179], v15 offset:2304
    v_mfma_f32_16x16x32_bf16 v[244:247], v[64:67], v[116:119], v[244:247]
    ds_read_b64 v[148:149], v14 offset:1280
    v_mfma_f32_16x16x32_bf16 v[244:247], v[68:71], v[112:115], v[244:247]
    ds_read_b64 v[150:151], v14 offset:1288
    v_mfma_f32_16x16x32_bf16 v[244:247], v[72:75], v[108:111], v[244:247]
    ds_read_b128 v[180:183], v15 offset:2816
    v_mfma_f32_16x16x32_bf16 v[244:247], v[76:79], v[104:107], v[244:247]
    ds_read_b64 v[152:153], v14 offset:768
    v_mfma_f32_16x16x32_bf16 v[244:247], v[80:83], v[100:103], v[244:247]
    ds_read_b64 v[154:155], v14 offset:776
    v_mfma_f32_16x16x32_bf16 v[244:247], v[84:87], v[96:99], v[244:247]
    ds_read_b128 v[184:187], v15 offset:3328
    v_mfma_f32_16x16x32_bf16 v[248:251], v[64:67], v[120:123], v[248:251]
    ds_read_b64 v[156:157], v14 offset:256
    v_mfma_f32_16x16x32_bf16 v[248:251], v[68:71], v[116:119], v[248:251]
    ds_read_b64 v[158:159], v14 offset:264
    v_mfma_f32_16x16x32_bf16 v[248:251], v[72:75], v[112:115], v[248:251]
    ds_read_b128 v[188:191], v15 offset:3840
    v_mfma_f32_16x16x32_bf16 v[248:251], v[76:79], v[108:111], v[248:251]
    v_mfma_f32_16x16x32_bf16 v[248:251], v[80:83], v[104:107], v[248:251]
    v_mfma_f32_16x16x32_bf16 v[248:251], v[84:87], v[100:103], v[248:251]
    v_mfma_f32_16x16x32_bf16 v[248:251], v[88:91], v[96:99], v[248:251]
    v_mfma_f32_16x16x32_bf16 v[252:255], v[64:67], v[124:127], v[252:255]
    v_mfma_f32_16x16x32_bf16 v[252:255], v[68:71], v[120:123], v[252:255]
    v_mfma_f32_16x16x32_bf16 v[252:255], v[72:75], v[116:119], v[252:255]
    v_mfma_f32_16x16x32_bf16 v[252:255], v[76:79], v[112:115], v[252:255]
    v_mfma_f32_16x16x32_bf16 v[252:255], v[80:83], v[108:111], v[252:255]
    v_mfma_f32_16x16x32_bf16 v[252:255], v[84:87], v[104:107], v[252:255]
    v_mfma_f32_16x16x32_bf16 v[252:255], v[88:91], v[100:103], v[252:255]
    v_mfma_f32_16x16x32_bf16 v[252:255], v[92:95], v[96:99], v[252:255]
    s_waitcnt lgkmcnt(0)
    v_mfma_f32_16x16x32_bf16 v[224:227], v[128:131], v[160:163], v[224:227]
    ds_read_b64 v[64:65], v14 offset:3776
    v_mfma_f32_16x16x32_bf16 v[228:231], v[128:131], v[164:167], v[228:231]
    ds_read_b64 v[66:67], v14 offset:3784
    v_mfma_f32_16x16x32_bf16 v[228:231], v[132:135], v[160:163], v[228:231]
    ds_read_b128 v[96:99], v15 offset:192
    v_mfma_f32_16x16x32_bf16 v[232:235], v[128:131], v[168:171], v[232:235]
    ds_read_b64 v[68:69], v14 offset:3264
    v_mfma_f32_16x16x32_bf16 v[232:235], v[132:135], v[164:167], v[232:235]
    ds_read_b64 v[70:71], v14 offset:3272
    v_mfma_f32_16x16x32_bf16 v[232:235], v[136:139], v[160:163], v[232:235]
    ds_read_b128 v[100:103], v15 offset:704
    v_mfma_f32_16x16x32_bf16 v[236:239], v[128:131], v[172:175], v[236:239]
    ds_read_b64 v[72:73], v14 offset:2752
    v_mfma_f32_16x16x32_bf16 v[236:239], v[132:135], v[168:171], v[236:239]
    ds_read_b64 v[74:75], v14 offset:2760
    v_mfma_f32_16x16x32_bf16 v[236:239], v[136:139], v[164:167], v[236:239]
    ds_read_b128 v[104:107], v15 offset:1216
    v_mfma_f32_16x16x32_bf16 v[236:239], v[140:143], v[160:163], v[236:239]
    ds_read_b64 v[76:77], v14 offset:2240
    v_mfma_f32_16x16x32_bf16 v[240:243], v[128:131], v[176:179], v[240:243]
    ds_read_b64 v[78:79], v14 offset:2248
    v_mfma_f32_16x16x32_bf16 v[240:243], v[132:135], v[172:175], v[240:243]
    ds_read_b128 v[108:111], v15 offset:1728
    v_mfma_f32_16x16x32_bf16 v[240:243], v[136:139], v[168:171], v[240:243]
    ds_read_b64 v[80:81], v14 offset:1728
    v_mfma_f32_16x16x32_bf16 v[240:243], v[140:143], v[164:167], v[240:243]
    ds_read_b64 v[82:83], v14 offset:1736
    v_mfma_f32_16x16x32_bf16 v[240:243], v[144:147], v[160:163], v[240:243]
    ds_read_b128 v[112:115], v15 offset:2240
    v_mfma_f32_16x16x32_bf16 v[244:247], v[128:131], v[180:183], v[244:247]
    ds_read_b64 v[84:85], v14 offset:1216
    v_mfma_f32_16x16x32_bf16 v[244:247], v[132:135], v[176:179], v[244:247]
    ds_read_b64 v[86:87], v14 offset:1224
    v_mfma_f32_16x16x32_bf16 v[244:247], v[136:139], v[172:175], v[244:247]
    ds_read_b128 v[116:119], v15 offset:2752
    v_mfma_f32_16x16x32_bf16 v[244:247], v[140:143], v[168:171], v[244:247]
    ds_read_b64 v[88:89], v14 offset:704
    v_mfma_f32_16x16x32_bf16 v[244:247], v[144:147], v[164:167], v[244:247]
    ds_read_b64 v[90:91], v14 offset:712
    v_mfma_f32_16x16x32_bf16 v[244:247], v[148:151], v[160:163], v[244:247]
    ds_read_b128 v[120:123], v15 offset:3264
    v_mfma_f32_16x16x32_bf16 v[248:251], v[128:131], v[184:187], v[248:251]
    ds_read_b64 v[92:93], v14 offset:192
    v_mfma_f32_16x16x32_bf16 v[248:251], v[132:135], v[180:183], v[248:251]
    ds_read_b64 v[94:95], v14 offset:200
    v_mfma_f32_16x16x32_bf16 v[248:251], v[136:139], v[176:179], v[248:251]
    ds_read_b128 v[124:127], v15 offset:3776
    v_mfma_f32_16x16x32_bf16 v[248:251], v[140:143], v[172:175], v[248:251]
    v_mfma_f32_16x16x32_bf16 v[248:251], v[144:147], v[168:171], v[248:251]
    v_mfma_f32_16x16x32_bf16 v[248:251], v[148:151], v[164:167], v[248:251]
    v_mfma_f32_16x16x32_bf16 v[248:251], v[152:155], v[160:163], v[248:251]
    v_mfma_f32_16x16x32_bf16 v[252:255], v[128:131], v[188:191], v[252:255]
    v_mfma_f32_16x16x32_bf16 v[252:255], v[132:135], v[184:187], v[252:255]
    v_mfma_f32_16x16x32_bf16 v[252:255], v[136:139], v[180:183], v[252:255]
    v_mfma_f32_16x16x32_bf16 v[252:255], v[140:143], v[176:179], v[252:255]
    v_mfma_f32_16x16x32_bf16 v[252:255], v[144:147], v[172:175], v[252:255]
    v_mfma_f32_16x16x32_bf16 v[252:255], v[148:151], v[168:171], v[252:255]
    v_mfma_f32_16x16x32_bf16 v[252:255], v[152:155], v[164:167], v[252:255]
    v_mfma_f32_16x16x32_bf16 v[252:255], v[156:159], v[160:163], v[252:255]
    s_waitcnt lgkmcnt(0)
    v_mfma_f32_16x16x32_bf16 v[224:227], v[64:67], v[96:99], v[224:227]
    ds_read_b64 v[128:129], v14 offset:3712
    v_mfma_f32_16x16x32_bf16 v[228:231], v[64:67], v[100:103], v[228:231]
    ds_read_b64 v[130:131], v14 offset:3720
    v_mfma_f32_16x16x32_bf16 v[228:231], v[68:71], v[96:99], v[228:231]
    ds_read_b128 v[160:163], v15 offset:128
    v_mfma_f32_16x16x32_bf16 v[232:235], v[64:67], v[104:107], v[232:235]
    ds_read_b64 v[132:133], v14 offset:3200
    v_mfma_f32_16x16x32_bf16 v[232:235], v[68:71], v[100:103], v[232:235]
    ds_read_b64 v[134:135], v14 offset:3208
    v_mfma_f32_16x16x32_bf16 v[232:235], v[72:75], v[96:99], v[232:235]
    ds_read_b128 v[164:167], v15 offset:640
    v_mfma_f32_16x16x32_bf16 v[236:239], v[64:67], v[108:111], v[236:239]
    ds_read_b64 v[136:137], v14 offset:2688
    v_mfma_f32_16x16x32_bf16 v[236:239], v[68:71], v[104:107], v[236:239]
    ds_read_b64 v[138:139], v14 offset:2696
    v_mfma_f32_16x16x32_bf16 v[236:239], v[72:75], v[100:103], v[236:239]
    ds_read_b128 v[168:171], v15 offset:1152
    v_mfma_f32_16x16x32_bf16 v[236:239], v[76:79], v[96:99], v[236:239]
    ds_read_b64 v[140:141], v14 offset:2176
    v_mfma_f32_16x16x32_bf16 v[240:243], v[64:67], v[112:115], v[240:243]
    ds_read_b64 v[142:143], v14 offset:2184
    v_mfma_f32_16x16x32_bf16 v[240:243], v[68:71], v[108:111], v[240:243]
    ds_read_b128 v[172:175], v15 offset:1664
    v_mfma_f32_16x16x32_bf16 v[240:243], v[72:75], v[104:107], v[240:243]
    ds_read_b64 v[144:145], v14 offset:1664
    v_mfma_f32_16x16x32_bf16 v[240:243], v[76:79], v[100:103], v[240:243]
    ds_read_b64 v[146:147], v14 offset:1672
    v_mfma_f32_16x16x32_bf16 v[240:243], v[80:83], v[96:99], v[240:243]
    ds_read_b128 v[176:179], v15 offset:2176
    v_mfma_f32_16x16x32_bf16 v[244:247], v[64:67], v[116:119], v[244:247]
    ds_read_b64 v[148:149], v14 offset:1152
    v_mfma_f32_16x16x32_bf16 v[244:247], v[68:71], v[112:115], v[244:247]
    ds_read_b64 v[150:151], v14 offset:1160
    v_mfma_f32_16x16x32_bf16 v[244:247], v[72:75], v[108:111], v[244:247]
    ds_read_b128 v[180:183], v15 offset:2688
    v_mfma_f32_16x16x32_bf16 v[244:247], v[76:79], v[104:107], v[244:247]
    ds_read_b64 v[152:153], v14 offset:640
    v_mfma_f32_16x16x32_bf16 v[244:247], v[80:83], v[100:103], v[244:247]
    ds_read_b64 v[154:155], v14 offset:648
    v_mfma_f32_16x16x32_bf16 v[244:247], v[84:87], v[96:99], v[244:247]
    ds_read_b128 v[184:187], v15 offset:3200
    v_mfma_f32_16x16x32_bf16 v[248:251], v[64:67], v[120:123], v[248:251]
    ds_read_b64 v[156:157], v14 offset:128
    v_mfma_f32_16x16x32_bf16 v[248:251], v[68:71], v[116:119], v[248:251]
    ds_read_b64 v[158:159], v14 offset:136
    v_mfma_f32_16x16x32_bf16 v[248:251], v[72:75], v[112:115], v[248:251]
    ds_read_b128 v[188:191], v15 offset:3712
    v_mfma_f32_16x16x32_bf16 v[248:251], v[76:79], v[108:111], v[248:251]
    v_mfma_f32_16x16x32_bf16 v[248:251], v[80:83], v[104:107], v[248:251]
    v_mfma_f32_16x16x32_bf16 v[248:251], v[84:87], v[100:103], v[248:251]
    v_mfma_f32_16x16x32_bf16 v[248:251], v[88:91], v[96:99], v[248:251]
    v_mfma_f32_16x16x32_bf16 v[252:255], v[64:67], v[124:127], v[252:255]
    v_mfma_f32_16x16x32_bf16 v[252:255], v[68:71], v[120:123], v[252:255]
    v_mfma_f32_16x16x32_bf16 v[252:255], v[72:75], v[116:119], v[252:255]
    v_mfma_f32_16x16x32_bf16 v[252:255], v[76:79], v[112:115], v[252:255]
    v_mfma_f32_16x16x32_bf16 v[252:255], v[80:83], v[108:111], v[252:255]
    v_mfma_f32_16x16x32_bf16 v[252:255], v[84:87], v[104:107], v[252:255]
    v_mfma_f32_16x16x32_bf16 v[252:255], v[88:91], v[100:103], v[252:255]
    v_mfma_f32_16x16x32_bf16 v[252:255], v[92:95], v[96:99], v[252:255]
    s_waitcnt lgkmcnt(0)
    v_mfma_f32_16x16x32_bf16 v[224:227], v[128:131], v[160:163], v[224:227]
    ds_read_b64 v[64:65], v14 offset:3648
    v_mfma_f32_16x16x32_bf16 v[228:231], v[128:131], v[164:167], v[228:231]
    ds_read_b64 v[66:67], v14 offset:3656
    v_mfma_f32_16x16x32_bf16 v[228:231], v[132:135], v[160:163], v[228:231]
    ds_read_b128 v[96:99], v15 offset:64
    v_mfma_f32_16x16x32_bf16 v[232:235], v[128:131], v[168:171], v[232:235]
    ds_read_b64 v[68:69], v14 offset:3136
    v_mfma_f32_16x16x32_bf16 v[232:235], v[132:135], v[164:167], v[232:235]
    ds_read_b64 v[70:71], v14 offset:3144
    v_mfma_f32_16x16x32_bf16 v[232:235], v[136:139], v[160:163], v[232:235]
    ds_read_b128 v[100:103], v15 offset:576
    v_mfma_f32_16x16x32_bf16 v[236:239], v[128:131], v[172:175], v[236:239]
    ds_read_b64 v[72:73], v14 offset:2624
    v_mfma_f32_16x16x32_bf16 v[236:239], v[132:135], v[168:171], v[236:239]
    ds_read_b64 v[74:75], v14 offset:2632
    v_mfma_f32_16x16x32_bf16 v[236:239], v[136:139], v[164:167], v[236:239]
    ds_read_b128 v[104:107], v15 offset:1088
    v_mfma_f32_16x16x32_bf16 v[236:239], v[140:143], v[160:163], v[236:239]
    ds_read_b64 v[76:77], v14 offset:2112
    v_mfma_f32_16x16x32_bf16 v[240:243], v[128:131], v[176:179], v[240:243]
    ds_read_b64 v[78:79], v14 offset:2120
    v_mfma_f32_16x16x32_bf16 v[240:243], v[132:135], v[172:175], v[240:243]
    ds_read_b128 v[108:111], v15 offset:1600
    v_mfma_f32_16x16x32_bf16 v[240:243], v[136:139], v[168:171], v[240:243]
    ds_read_b64 v[80:81], v14 offset:1600
    v_mfma_f32_16x16x32_bf16 v[240:243], v[140:143], v[164:167], v[240:243]
    ds_read_b64 v[82:83], v14 offset:1608
    v_mfma_f32_16x16x32_bf16 v[240:243], v[144:147], v[160:163], v[240:243]
    ds_read_b128 v[112:115], v15 offset:2112
    v_mfma_f32_16x16x32_bf16 v[244:247], v[128:131], v[180:183], v[244:247]
    ds_read_b64 v[84:85], v14 offset:1088
    v_mfma_f32_16x16x32_bf16 v[244:247], v[132:135], v[176:179], v[244:247]
    ds_read_b64 v[86:87], v14 offset:1096
    v_mfma_f32_16x16x32_bf16 v[244:247], v[136:139], v[172:175], v[244:247]
    ds_read_b128 v[116:119], v15 offset:2624
    v_mfma_f32_16x16x32_bf16 v[244:247], v[140:143], v[168:171], v[244:247]
    ds_read_b64 v[88:89], v14 offset:576
    v_mfma_f32_16x16x32_bf16 v[244:247], v[144:147], v[164:167], v[244:247]
    ds_read_b64 v[90:91], v14 offset:584
    v_mfma_f32_16x16x32_bf16 v[244:247], v[148:151], v[160:163], v[244:247]
    ds_read_b128 v[120:123], v15 offset:3136
    v_mfma_f32_16x16x32_bf16 v[248:251], v[128:131], v[184:187], v[248:251]
    ds_read_b64 v[92:93], v14 offset:64
    v_mfma_f32_16x16x32_bf16 v[248:251], v[132:135], v[180:183], v[248:251]
    ds_read_b64 v[94:95], v14 offset:72
    v_mfma_f32_16x16x32_bf16 v[248:251], v[136:139], v[176:179], v[248:251]
    ds_read_b128 v[124:127], v15 offset:3648
    v_mfma_f32_16x16x32_bf16 v[248:251], v[140:143], v[172:175], v[248:251]
    v_mfma_f32_16x16x32_bf16 v[248:251], v[144:147], v[168:171], v[248:251]
    v_mfma_f32_16x16x32_bf16 v[248:251], v[148:151], v[164:167], v[248:251]
    v_mfma_f32_16x16x32_bf16 v[248:251], v[152:155], v[160:163], v[248:251]
    v_mfma_f32_16x16x32_bf16 v[252:255], v[128:131], v[188:191], v[252:255]
    v_mfma_f32_16x16x32_bf16 v[252:255], v[132:135], v[184:187], v[252:255]
    v_mfma_f32_16x16x32_bf16 v[252:255], v[136:139], v[180:183], v[252:255]
    v_mfma_f32_16x16x32_bf16 v[252:255], v[140:143], v[176:179], v[252:255]
    v_mfma_f32_16x16x32_bf16 v[252:255], v[144:147], v[172:175], v[252:255]
    v_mfma_f32_16x16x32_bf16 v[252:255], v[148:151], v[168:171], v[252:255]
    v_mfma_f32_16x16x32_bf16 v[252:255], v[152:155], v[164:167], v[252:255]
    v_mfma_f32_16x16x32_bf16 v[252:255], v[156:159], v[160:163], v[252:255]
    s_waitcnt lgkmcnt(0)
    v_mfma_f32_16x16x32_bf16 v[224:227], v[64:67], v[96:99], v[224:227]
    ds_read_b64 v[128:129], v14 offset:3584
    v_mfma_f32_16x16x32_bf16 v[228:231], v[64:67], v[100:103], v[228:231]
    ds_read_b64 v[130:131], v14 offset:3592
    v_mfma_f32_16x16x32_bf16 v[228:231], v[68:71], v[96:99], v[228:231]
    ds_read_b128 v[160:163], v15 offset:0
    v_mfma_f32_16x16x32_bf16 v[232:235], v[64:67], v[104:107], v[232:235]
    ds_read_b64 v[132:133], v14 offset:3072
    v_mfma_f32_16x16x32_bf16 v[232:235], v[68:71], v[100:103], v[232:235]
    ds_read_b64 v[134:135], v14 offset:3080
    v_mfma_f32_16x16x32_bf16 v[232:235], v[72:75], v[96:99], v[232:235]
    ds_read_b128 v[164:167], v15 offset:512
    v_mfma_f32_16x16x32_bf16 v[236:239], v[64:67], v[108:111], v[236:239]
    ds_read_b64 v[136:137], v14 offset:2560
    v_mfma_f32_16x16x32_bf16 v[236:239], v[68:71], v[104:107], v[236:239]
    ds_read_b64 v[138:139], v14 offset:2568
    v_mfma_f32_16x16x32_bf16 v[236:239], v[72:75], v[100:103], v[236:239]
    ds_read_b128 v[168:171], v15 offset:1024
    v_mfma_f32_16x16x32_bf16 v[236:239], v[76:79], v[96:99], v[236:239]
    ds_read_b64 v[140:141], v14 offset:2048
    v_mfma_f32_16x16x32_bf16 v[240:243], v[64:67], v[112:115], v[240:243]
    ds_read_b64 v[142:143], v14 offset:2056
    buffer_load_dword v18, v13, s[16:19], 0 offen sc1
    v_mfma_f32_16x16x32_bf16 v[240:243], v[68:71], v[108:111], v[240:243]
    ds_read_b128 v[172:175], v15 offset:1536
    v_mfma_f32_16x16x32_bf16 v[240:243], v[72:75], v[104:107], v[240:243]
    ds_read_b64 v[144:145], v14 offset:1536
    v_mfma_f32_16x16x32_bf16 v[240:243], v[76:79], v[100:103], v[240:243]
    ds_read_b64 v[146:147], v14 offset:1544
    v_mfma_f32_16x16x32_bf16 v[240:243], v[80:83], v[96:99], v[240:243]
    ds_read_b128 v[176:179], v15 offset:2048
    v_mfma_f32_16x16x32_bf16 v[244:247], v[64:67], v[116:119], v[244:247]
    ds_read_b64 v[148:149], v14 offset:1024
    v_mfma_f32_16x16x32_bf16 v[244:247], v[68:71], v[112:115], v[244:247]
    ds_read_b64 v[150:151], v14 offset:1032
    v_mfma_f32_16x16x32_bf16 v[244:247], v[72:75], v[108:111], v[244:247]
    ds_read_b128 v[180:183], v15 offset:2560
    v_mfma_f32_16x16x32_bf16 v[244:247], v[76:79], v[104:107], v[244:247]
    ds_read_b64 v[152:153], v14 offset:512
    v_mfma_f32_16x16x32_bf16 v[244:247], v[80:83], v[100:103], v[244:247]
    ds_read_b64 v[154:155], v14 offset:520
    v_mfma_f32_16x16x32_bf16 v[244:247], v[84:87], v[96:99], v[244:247]
    ds_read_b128 v[184:187], v15 offset:3072
    v_mfma_f32_16x16x32_bf16 v[248:251], v[64:67], v[120:123], v[248:251]
    ds_read_b64 v[156:157], v14 offset:0
    v_mfma_f32_16x16x32_bf16 v[248:251], v[68:71], v[116:119], v[248:251]
    ds_read_b64 v[158:159], v14 offset:8
    v_mfma_f32_16x16x32_bf16 v[248:251], v[72:75], v[112:115], v[248:251]
    ds_read_b128 v[188:191], v15 offset:3584
    v_mfma_f32_16x16x32_bf16 v[248:251], v[76:79], v[108:111], v[248:251]
    v_mfma_f32_16x16x32_bf16 v[248:251], v[80:83], v[104:107], v[248:251]
    v_mfma_f32_16x16x32_bf16 v[248:251], v[84:87], v[100:103], v[248:251]
    v_mfma_f32_16x16x32_bf16 v[248:251], v[88:91], v[96:99], v[248:251]
    v_mfma_f32_16x16x32_bf16 v[252:255], v[64:67], v[124:127], v[252:255]
    v_mfma_f32_16x16x32_bf16 v[252:255], v[68:71], v[120:123], v[252:255]
    v_mfma_f32_16x16x32_bf16 v[252:255], v[72:75], v[116:119], v[252:255]
    v_mfma_f32_16x16x32_bf16 v[252:255], v[76:79], v[112:115], v[252:255]
    v_mfma_f32_16x16x32_bf16 v[252:255], v[80:83], v[108:111], v[252:255]
    v_mfma_f32_16x16x32_bf16 v[252:255], v[84:87], v[104:107], v[252:255]
    v_mfma_f32_16x16x32_bf16 v[252:255], v[88:91], v[100:103], v[252:255]
    v_mfma_f32_16x16x32_bf16 v[252:255], v[92:95], v[96:99], v[252:255]
    s_waitcnt lgkmcnt(0)
    s_waitcnt vmcnt(0)
    v_cmp_ne_u32 vcc, 1, v18
    s_nop 0
    s_and_b32 s91, vcc_lo, 0x7ffffff
    s_and_b32 s92, vcc_lo, 0xfff
    s_barrier
    s_cbranch_scc1 L_c7_late
    v_mfma_f32_16x16x32_bf16 v[224:227], v[128:131], v[160:163], v[224:227]
    s_mul_i32 s80, s70, 5120
    v_mfma_f32_16x16x32_bf16 v[228:231], v[128:131], v[164:167], v[228:231]
    s_add_u32 s81, s64, 0
    buffer_load_dwordx4 v[16:19], v10, s[16:19], s81 offen sc1
    v_mfma_f32_16x16x32_bf16 v[228:231], v[132:135], v[160:163], v[228:231]
    v_add_u32 v8, s80, v1
    v_mfma_f32_16x16x32_bf16 v[232:235], v[128:131], v[168:171], v[232:235]
    buffer_load_dwordx4 v[20:23], v11, s[16:19], s81 offen sc1
    v_mfma_f32_16x16x32_bf16 v[232:235], v[132:135], v[164:167], v[232:235]
    v_add_u32 v9, 61440, v8
    v_mfma_f32_16x16x32_bf16 v[232:235], v[136:139], v[160:163], v[232:235]
    s_add_u32 s81, s64, 40960
    buffer_load_dwordx4 v[24:27], v10, s[16:19], s81 offen sc1
    v_mfma_f32_16x16x32_bf16 v[236:239], v[128:131], v[172:175], v[236:239]
    ds_read_b128 v[104:107], v8 offset:0
    v_mfma_f32_16x16x32_bf16 v[236:239], v[132:135], v[168:171], v[236:239]
    v_mfma_f32_16x16x32_bf16 v[236:239], v[136:139], v[164:167], v[236:239]
    ds_read_b128 v[108:111], v8 offset:1024
    buffer_load_dwordx4 v[28:31], v11, s[16:19], s81 offen sc1
    v_mfma_f32_16x16x32_bf16 v[236:239], v[140:143], v[160:163], v[236:239]
    v_mfma_f32_16x16x32_bf16 v[240:243], v[128:131], v[176:179], v[240:243]
    ds_read_b128 v[112:115], v8 offset:2048
    s_add_u32 s81, s64, 81920
    buffer_load_dwordx4 v[32:35], v10, s[16:19], s81 offen sc1
    v_mfma_f32_16x16x32_bf16 v[240:243], v[132:135], v[172:175], v[240:243]
    v_mfma_f32_16x16x32_bf16 v[240:243], v[136:139], v[168:171], v[240:243]
    ds_read_b128 v[116:119], v8 offset:3072
    v_mfma_f32_16x16x32_bf16 v[240:243], v[140:143], v[164:167], v[240:243]
    buffer_load_dwordx4 v[36:39], v11, s[16:19], s81 offen sc1
    v_mfma_f32_16x16x32_bf16 v[240:243], v[144:147], v[160:163], v[240:243]
    ds_read_b128 v[120:123], v8 offset:4096
    v_mfma_f32_16x16x32_bf16 v[244:247], v[128:131], v[180:183], v[244:247]
    s_add_u32 s81, s64, 122880
    buffer_load_dwordx4 v[40:43], v10, s[16:19], s81 offen sc1
    v_mfma_f32_16x16x32_bf16 v[244:247], v[132:135], v[176:179], v[244:247]
    v_mfma_f32_16x16x32_bf16 v[244:247], v[136:139], v[172:175], v[244:247]
    v_mfma_f32_16x16x32_bf16 v[244:247], v[140:143], v[168:171], v[244:247]
    buffer_load_dwordx4 v[44:47], v11, s[16:19], s81 offen sc1
    v_mfma_f32_16x16x32_bf16 v[244:247], v[144:147], v[164:167], v[244:247]
    v_mfma_f32_16x16x32_bf16 v[244:247], v[148:151], v[160:163], v[244:247]
    s_add_u32 s81, s65, 0
    buffer_load_dwordx4 v[48:51], v10, s[16:19], s81 offen sc1
    v_mfma_f32_16x16x32_bf16 v[248:251], v[128:131], v[184:187], v[248:251]
    v_mfma_f32_16x16x32_bf16 v[248:251], v[132:135], v[180:183], v[248:251]
    v_mfma_f32_16x16x32_bf16 v[248:251], v[136:139], v[176:179], v[248:251]
    buffer_load_dwordx4 v[52:55], v11, s[16:19], s81 offen sc1
    v_mfma_f32_16x16x32_bf16 v[248:251], v[140:143], v[172:175], v[248:251]
    v_mfma_f32_16x16x32_bf16 v[248:251], v[144:147], v[168:171], v[248:251]
    s_add_u32 s81, s65, 40960
    buffer_load_dwordx4 v[56:59], v10, s[16:19], s81 offen sc1
    v_mfma_f32_16x16x32_bf16 v[248:251], v[148:151], v[164:167], v[248:251]
    v_mfma_f32_16x16x32_bf16 v[248:251], v[152:155], v[160:163], v[248:251]
    v_mfma_f32_16x16x32_bf16 v[252:255], v[128:131], v[188:191], v[252:255]
    buffer_load_dwordx4 v[60:63], v11, s[16:19], s81 offen sc1
    v_mfma_f32_16x16x32_bf16 v[252:255], v[132:135], v[184:187], v[252:255]
    v_mfma_f32_16x16x32_bf16 v[252:255], v[136:139], v[180:183], v[252:255]
    s_add_u32 s81, s65, 81920
    buffer_load_dwordx4 v[192:195], v10, s[16:19], s81 offen sc1
    v_mfma_f32_16x16x32_bf16 v[252:255], v[140:143], v[176:179], v[252:255]
    v_mfma_f32_16x16x32_bf16 v[252:255], v[144:147], v[172:175], v[252:255]
    v_mfma_f32_16x16x32_bf16 v[252:255], v[148:151], v[168:171], v[252:255]
    buffer_load_dwordx4 v[196:199], v11, s[16:19], s81 offen sc1
    v_mfma_f32_16x16x32_bf16 v[252:255], v[152:155], v[164:167], v[252:255]
    v_mfma_f32_16x16x32_bf16 v[252:255], v[156:159], v[160:163], v[252:255]
    s_branch L_comp_g2
L_c7_late:
    v_mfma_f32_16x16x32_bf16 v[224:227], v[128:131], v[160:163], v[224:227]
    s_mul_i32 s80, s70, 5120
    v_mfma_f32_16x16x32_bf16 v[228:231], v[128:131], v[164:167], v[228:231]
    v_mfma_f32_16x16x32_bf16 v[228:231], v[132:135], v[160:163], v[228:231]
    v_add_u32 v8, s80, v1
    v_mfma_f32_16x16x32_bf16 v[232:235], v[128:131], v[168:171], v[232:235]
    v_mfma_f32_16x16x32_bf16 v[232:235], v[132:135], v[164:167], v[232:235]
    v_add_u32 v9, 61440, v8
    v_mfma_f32_16x16x32_bf16 v[232:235], v[136:139], v[160:163], v[232:235]
    v_mfma_f32_16x16x32_bf16 v[236:239], v[128:131], v[172:175], v[236:239]
    ds_read_b128 v[104:107], v8 offset:0
    v_mfma_f32_16x16x32_bf16 v[236:239], v[132:135], v[168:171], v[236:239]
    v_mfma_f32_16x16x32_bf16 v[236:239], v[136:139], v[164:167], v[236:239]
    ds_read_b128 v[108:111], v8 offset:1024
    v_mfma_f32_16x16x32_bf16 v[236:239], v[140:143], v[160:163], v[236:239]
    v_mfma_f32_16x16x32_bf16 v[240:243], v[128:131], v[176:179], v[240:243]
    ds_read_b128 v[112:115], v8 offset:2048
    v_mfma_f32_16x16x32_bf16 v[240:243], v[132:135], v[172:175], v[240:243]
    v_mfma_f32_16x16x32_bf16 v[240:243], v[136:139], v[168:171], v[240:243]
    ds_read_b128 v[116:119], v8 offset:3072
    v_mfma_f32_16x16x32_bf16 v[240:243], v[140:143], v[164:167], v[240:243]
    v_mfma_f32_16x16x32_bf16 v[240:243], v[144:147], v[160:163], v[240:243]
    ds_read_b128 v[120:123], v8 offset:4096
    v_mfma_f32_16x16x32_bf16 v[244:247], v[128:131], v[180:183], v[244:247]
    v_mfma_f32_16x16x32_bf16 v[244:247], v[132:135], v[176:179], v[244:247]
    v_mfma_f32_16x16x32_bf16 v[244:247], v[136:139], v[172:175], v[244:247]
    v_mfma_f32_16x16x32_bf16 v[244:247], v[140:143], v[168:171], v[244:247]
    v_mfma_f32_16x16x32_bf16 v[244:247], v[144:147], v[164:167], v[244:247]
    v_mfma_f32_16x16x32_bf16 v[244:247], v[148:151], v[160:163], v[244:247]
    v_mfma_f32_16x16x32_bf16 v[248:251], v[128:131], v[184:187], v[248:251]
    v_mfma_f32_16x16x32_bf16 v[248:251], v[132:135], v[180:183], v[248:251]
    v_mfma_f32_16x16x32_bf16 v[248:251], v[136:139], v[176:179], v[248:251]
    v_mfma_f32_16x16x32_bf16 v[248:251], v[140:143], v[172:175], v[248:251]
    v_mfma_f32_16x16x32_bf16 v[248:251], v[144:147], v[168:171], v[248:251]
    v_mfma_f32_16x16x32_bf16 v[248:251], v[148:151], v[164:167], v[248:251]
    v_mfma_f32_16x16x32_bf16 v[248:251], v[152:155], v[160:163], v[248:251]
    v_mfma_f32_16x16x32_bf16 v[252:255], v[128:131], v[188:191], v[252:255]
    v_mfma_f32_16x16x32_bf16 v[252:255], v[132:135], v[184:187], v[252:255]
    v_mfma_f32_16x16x32_bf16 v[252:255], v[136:139], v[180:183], v[252:255]
    v_mfma_f32_16x16x32_bf16 v[252:255], v[140:143], v[176:179], v[252:255]
    v_mfma_f32_16x16x32_bf16 v[252:255], v[144:147], v[172:175], v[252:255]
    v_mfma_f32_16x16x32_bf16 v[252:255], v[148:151], v[168:171], v[252:255]
    v_mfma_f32_16x16x32_bf16 v[252:255], v[152:155], v[164:167], v[252:255]
    v_mfma_f32_16x16x32_bf16 v[252:255], v[156:159], v[160:163], v[252:255]
    s_mov_b32 s90, 0
L_poll_1:
    buffer_load_dword v18, v13, s[16:19], 0 offen sc1
    s_waitcnt vmcnt(0)
    v_cmp_ne_u32 vcc, 1, v18
    s_nop 0
    s_and_b32 s91, vcc_lo, 0x7ffffff
    s_and_b32 s92, vcc_lo, 0xfff
    s_cbranch_scc0 L_pdone_2
    s_sleep 4
    s_add_u32 s90, s90, 1
    s_cmp_lt_u32 s90, 40000
    s_cbranch_scc1 L_poll_1
L_pdone_2:
    s_add_u32 s80, s64, 0
    buffer_load_dwordx4 v[16:19], v10, s[16:19], s80 offen sc1
    buffer_load_dwordx4 v[20:23], v11, s[16:19], s80 offen sc1
    s_add_u32 s80, s64, 40960
    buffer_load_dwordx4 v[24:27], v10, s[16:19], s80 offen sc1
    buffer_load_dwordx4 v[28:31], v11, s[16:19], s80 offen sc1
    s_add_u32 s80, s64, 81920
    buffer_load_dwordx4 v[32:35], v10, s[16:19], s80 offen sc1
    buffer_load_dwordx4 v[36:39], v11, s[16:19], s80 offen sc1
    s_add_u32 s80, s64, 122880
    buffer_load_dwordx4 v[40:43], v10, s[16:19], s80 offen sc1
    buffer_load_dwordx4 v[44:47], v11, s[16:19], s80 offen sc1
    s_add_u32 s80, s65, 0
    buffer_load_dwordx4 v[48:51], v10, s[16:19], s80 offen sc1
    buffer_load_dwordx4 v[52:55], v11, s[16:19], s80 offen sc1
    s_add_u32 s80, s65, 40960
    buffer_load_dwordx4 v[56:59], v10, s[16:19], s80 offen sc1
    buffer_load_dwordx4 v[60:63], v11, s[16:19], s80 offen sc1
    s_add_u32 s80, s65, 81920
    buffer_load_dwordx4 v[192:195], v10, s[16:19], s80 offen sc1
    buffer_load_dwordx4 v[196:199], v11, s[16:19], s80 offen sc1
    s_branch L_comp_g2
L_f2:
    s_waitcnt vmcnt(0)
    v_mov_b32 v18, 0
    v_mov_b32 v19, 1
    s_mov_b64 exec, 1
    buffer_store_dword v19, v18, s[16:19], s35 offen sc1
    s_mov_b64 exec, -1
    s_branch L_f2r
L_f1_s:
    v_mov_b32 v18, 0
    v_mov_b32 v19, 1
    s_mov_b64 exec, 1
    buffer_store_dword v19, v18, s[16:19], s44 offen sc1
    s_mov_b64 exec, -1
    s_branch L_f1r_s
L_f1_l:
    v_mov_b32 v18, 0
    v_mov_b32 v19, 1
    s_mov_b64 exec, 1
    buffer_store_dword v19, v18, s[16:19], s44 offen sc1
    s_mov_b64 exec, -1
    s_branch L_f1r_l
L_comp_large:
    s_sub_u32 s82, s81, 20
    s_add_u32 s83, s80, s3
    s_cmp_eq_u32 s83, 0
    s_cselect_b32 s32, s82, 63
    s_cmp_lt_u32 s32, 1
    s_cbranch_scc0 L_nclr_3
    v_mov_b64 v[16:17], 0
    v_mov_b64 v[18:19], 0
    s_mul_i32 s80, s32, 40960
    buffer_store_dwordx4 v[16:19], v1, s[16:19], s80 offen offset:0 sc1
    buffer_store_dwordx4 v[16:19], v1, s[16:19], s80 offen offset:1024 sc1
    buffer_store_dwordx4 v[16:19], v1, s[16:19], s80 offen offset:2048 sc1
    buffer_store_dwordx4 v[16:19], v1, s[16:19], s80 offen offset:3072 sc1
    s_add_u32 s80, s80, 4096
    buffer_store_dwordx4 v[16:19], v1, s[16:19], s80 offen offset:0 sc1
    buffer_store_dwordx4 v[16:19], v1, s[16:19], s80 offen offset:1024 sc1
    buffer_store_dwordx4 v[16:19], v1, s[16:19], s80 offen offset:2048 sc1
    buffer_store_dwordx4 v[16:19], v1, s[16:19], s80 offen offset:3072 sc1
    s_add_u32 s80, s80, 4096
    buffer_store_dwordx4 v[16:19], v1, s[16:19], s80 offen offset:0 sc1
    buffer_store_dwordx4 v[16:19], v1, s[16:19], s80 offen offset:1024 sc1
    buffer_store_dwordx4 v[16:19], v1, s[16:19], s80 offen offset:2048 sc1
    buffer_store_dwordx4 v[16:19], v1, s[16:19], s80 offen offset:3072 sc1
    s_add_u32 s80, s80, 4096
    buffer_store_dwordx4 v[16:19], v1, s[16:19], s80 offen offset:0 sc1
    buffer_store_dwordx4 v[16:19], v1, s[16:19], s80 offen offset:1024 sc1
    buffer_store_dwordx4 v[16:19], v1, s[16:19], s80 offen offset:2048 sc1
    buffer_store_dwordx4 v[16:19], v1, s[16:19], s80 offen offset:3072 sc1
    s_add_u32 s80, s80, 4096
    buffer_store_dwordx4 v[16:19], v1, s[16:19], s80 offen offset:0 sc1
    buffer_store_dwordx4 v[16:19], v1, s[16:19], s80 offen offset:1024 sc1
    buffer_store_dwordx4 v[16:19], v1, s[16:19], s80 offen offset:2048 sc1
    buffer_store_dwordx4 v[16:19], v1, s[16:19], s80 offen offset:3072 sc1
    s_add_u32 s80, s80, 4096
    buffer_store_dwordx4 v[16:19], v1, s[16:19], s80 offen offset:0 sc1
    buffer_store_dwordx4 v[16:19], v1, s[16:19], s80 offen offset:1024 sc1
    buffer_store_dwordx4 v[16:19], v1, s[16:19], s80 offen offset:2048 sc1
    buffer_store_dwordx4 v[16:19], v1, s[16:19], s80 offen offset:3072 sc1
    s_add_u32 s80, s80, 4096
    buffer_store_dwordx4 v[16:19], v1, s[16:19], s80 offen offset:0 sc1
    buffer_store_dwordx4 v[16:19], v1, s[16:19], s80 offen offset:1024 sc1
    buffer_store_dwordx4 v[16:19], v1, s[16:19], s80 offen offset:2048 sc1
    buffer_store_dwordx4 v[16:19], v1, s[16:19], s80 offen offset:3072 sc1
    s_add_u32 s80, s80, 4096
    buffer_store_dwordx4 v[16:19], v1, s[16:19], s80 offen offset:0 sc1
    buffer_store_dwordx4 v[16:19], v1, s[16:19], s80 offen offset:1024 sc1
    buffer_store_dwordx4 v[16:19], v1, s[16:19], s80 offen offset:2048 sc1
    buffer_store_dwordx4 v[16:19], v1, s[16:19], s80 offen offset:3072 sc1
    s_add_u32 s80, s80, 4096
    buffer_store_dwordx4 v[16:19], v1, s[16:19], s80 offen offset:0 sc1
    buffer_store_dwordx4 v[16:19], v1, s[16:19], s80 offen offset:1024 sc1
    buffer_store_dwordx4 v[16:19], v1, s[16:19], s80 offen offset:2048 sc1
    buffer_store_dwordx4 v[16:19], v1, s[16:19], s80 offen offset:3072 sc1
    s_add_u32 s80, s80, 4096
    buffer_store_dwordx4 v[16:19], v1, s[16:19], s80 offen offset:0 sc1
    buffer_store_dwordx4 v[16:19], v1, s[16:19], s80 offen offset:1024 sc1
    buffer_store_dwordx4 v[16:19], v1, s[16:19], s80 offen offset:2048 sc1
    buffer_store_dwordx4 v[16:19], v1, s[16:19], s80 offen offset:3072 sc1
L_nclr_3:
    s_lshr_b32 s70, s3, 1
    s_and_b32 s71, s3, 1
    v_and_b32 v3, 31, v2
    v_lshrrev_b32 v4, 5, v2
    v_lshrrev_b32 v5, 1, v3
    v_and_b32 v5, 7, v5
    v_xor_b32 v5, v5, v4
    v_lshlrev_b32 v5, 4, v5
    s_mul_i32 s80, s70, 16384
    v_lshlrev_b32 v3, 7, v3
    v_add3_u32 v9, v3, v5, s80
    v_xor_b32 v10, 32, v9
    v_xor_b32 v11, 64, v9
    v_xor_b32 v12, 96, v9
    v_lshlrev_b32 v3, 3, v4
    v_bfe_u32 v5, v2, 2, 2
    v_add_u32 v3, v3, v5
    v_lshlrev_b32 v3, 7, v3
    v_bfe_u32 v5, v2, 3, 1
    v_xor_b32 v5, s71, v5
    v_lshlrev_b32 v5, 6, v5
    v_add_u32 v3, v3, v5
    v_bfe_u32 v5, v2, 4, 1
    v_lshlrev_b32 v5, 5, v5
    v_add_u32 v3, v3, v5
    v_and_b32 v5, 3, v2
    v_lshlrev_b32 v5, 3, v5
    s_mov_b32 s80, 32768
    v_add3_u32 v8, v3, v5, s80
    s_mov_b32 s72, 0
    s_mov_b32 s73, 1
    s_mov_b32 s74, 49152
    s_mov_b32 s75, 49152
    s_add_u32 s85, s59, s60
    s_cmp_ge_u32 s85, 10
    s_cselect_b32 s86, 10, 0
    s_sub_u32 s85, s85, s86
    s_lshl_b32 s85, s85, 2
    s_add_u32 s85, s85, s56
    s_lshl_b32 s85, s85, 7
    s_lshl_b32 s86, s61, 2
    s_add_u32 s85, s85, s86
    s_add_u32 s44, s85, 0
    s_add_u32 s45, s60, 2
    v_bfe_u32 v3, v2, 4, 1
    v_lshlrev_b32 v3, 10, v3
    v_lshrrev_b32 v4, 5, v2
    v_lshlrev_b32 v4, 9, v4
    v_and_b32 v5, 15, v2
    v_lshlrev_b32 v5, 4, v5
    v_add3_u32 v16, v3, v4, v5
    s_lshl_b32 s80, s52, 1
    s_add_u32 s80, s80, s71
    s_lshl_b32 s81, s80, 12
    s_add_u32 s81, s81, 7733248
    s_mul_i32 s82, s70, 4
    s_lshr_b32 s83, s53, 5
    s_add_u32 s82, s82, s83
    s_lshl_b32 s84, s82, 8
    s_lshl_b32 s80, s80, 2
    s_add_u32 s84, s84, s80
    s_add_u32 s61, s84, 18432
    s_lshr_b32 s83, s82, 1
    s_mul_i32 s83, s83, 221184
    s_and_b32 s84, s82, 1
    s_lshl_b32 s84, s84, 11
    s_add_u32 s83, s83, s84
    s_add_u32 s76, s83, s81
    s_add_u32 s82, s82, 1
    s_lshr_b32 s83, s82, 1
    s_mul_i32 s83, s83, 221184
    s_and_b32 s84, s82, 1
    s_lshl_b32 s84, s84, 11
    s_add_u32 s83, s83, s84
    s_add_u32 s77, s83, s81
    s_add_u32 s82, s82, 1
    s_lshr_b32 s83, s82, 1
    s_mul_i32 s83, s83, 221184
    s_and_b32 s84, s82, 1
    s_lshl_b32 s84, s84, 11
    s_add_u32 s83, s83, s84
    s_add_u32 s78, s83, s81
    s_add_u32 s82, s82, 1
    s_lshr_b32 s83, s82, 1
    s_mul_i32 s83, s83, 221184
    s_and_b32 s84, s82, 1
    s_lshl_b32 s84, s84, 11
    s_add_u32 s83, s83, s84
    s_add_u32 s79, s83, s81
    s_add_u32 s82, s82, 1
    s_mul_i32 s69, s57, 221184
    s_lshl_b32 s80, s70, 12
    s_add_u32 s69, s69, s80
    s_lshl_b32 s80, s71, 11
    s_add_u32 s69, s69, s80
    s_add_u32 s69, s69, 7733248
    s_and_b32 s80, s57, 15
    s_mul_i32 s80, s80, 11
    s_lshr_b32 s80, s80, 5
    s_min_u32 s80, s80, 4
    s_add_u32 s81, s80, 1
    s_cmp_ge_u32 s81, 5
    s_cselect_b32 s93, 5, 0
    s_sub_u32 s81, s81, s93
    s_mul_i32 s81, s81, 8192
    s_add_u32 s64, s81, s69
    s_add_u32 s81, s80, 2
    s_cmp_ge_u32 s81, 5
    s_cselect_b32 s93, 5, 0
    s_sub_u32 s81, s81, s93
    s_mul_i32 s81, s81, 8192
    s_add_u32 s65, s81, s69
    s_add_u32 s81, s80, 3
    s_cmp_ge_u32 s81, 5
    s_cselect_b32 s93, 5, 0
    s_sub_u32 s81, s81, s93
    s_mul_i32 s81, s81, 8192
    s_add_u32 s66, s81, s69
    s_add_u32 s81, s80, 4
    s_cmp_ge_u32 s81, 5
    s_cselect_b32 s93, 5, 0
    s_sub_u32 s81, s81, s93
    s_mul_i32 s81, s81, 8192
    s_add_u32 s67, s81, s69
    s_add_u32 s81, s80, 5
    s_cmp_ge_u32 s81, 5
    s_cselect_b32 s93, 5, 0
    s_sub_u32 s81, s81, s93
    s_mul_i32 s81, s81, 8192
    s_add_u32 s68, s81, s69
    s_add_u32 s80, s80, 1
    v_lshrrev_b32 v3, 2, v2
    v_add_u32 v3, s80, v3
    v_subrev_u32 v4, 5, v3
    v_cmp_gt_u32 vcc, 5, v3
    s_nop 1
    v_cndmask_b32 v3, v4, v3, vcc
    v_and_b32 v4, 3, v2
    v_mad_u32_u24 v3, v4, 5, v3
    v_min_u32 v4, 26, v2
    v_cmp_gt_u32 vcc, 20, v2
    s_nop 1
    v_cndmask_b32 v3, v4, v3, vcc
    v_lshlrev_b32 v3, 3, v3
    s_lshl_b32 s80, s57, 1
    s_add_u32 s80, s80, s71
    s_lshl_b32 s80, s80, 8
    s_lshl_b32 s81, s70, 2
    s_add_u32 s80, s80, s81
    s_add_u32 s80, s80, 18432
    v_add_u32 v13, s80, v3
    s_cmp_lt_u32 s32, 1
    s_cbranch_scc0 L_sig_4
    s_waitcnt vmcnt(0)
    v_mov_b32 v18, 0
    v_mov_b32 v19, 1
    s_lshl_b32 s80, s32, 2
    s_mov_b64 exec, 1
    buffer_store_dword v19, v18, s[28:31], s80 offen sc1
    s_mov_b64 exec, -1
L_sig_4:
    s_setprio 1
    s_barrier
    ds_read_b64_tr_b16 v[64:65], v8 offset:0
    ds_read_b64_tr_b16 v[66:67], v8 offset:512
    ds_read_b128 v[72:75], v9
    ds_read_b64_tr_b16 v[68:69], v8 offset:8192
    ds_read_b64_tr_b16 v[70:71], v8 offset:8704
    ds_read_b128 v[76:79], v9 offset:4096
    ds_read_b128 v[80:83], v9 offset:8192
    ds_read_b128 v[84:87], v9 offset:12288
    s_waitcnt lgkmcnt(0)
    v_mfma_f32_32x32x16_bf16 v[128:143], v[64:67], v[72:75], 0
    ds_read_b64_tr_b16 v[88:89], v8 offset:2048
    ds_read_b64_tr_b16 v[90:91], v8 offset:2560
    v_mfma_f32_32x32x16_bf16 v[144:159], v[68:71], v[72:75], 0
    ds_read_b128 v[96:99], v10
    ds_read_b64_tr_b16 v[92:93], v8 offset:10240
    v_mfma_f32_32x32x16_bf16 v[160:175], v[64:67], v[76:79], 0
    ds_read_b64_tr_b16 v[94:95], v8 offset:10752
    ds_read_b128 v[100:103], v10 offset:4096
    v_mfma_f32_32x32x16_bf16 v[176:191], v[68:71], v[76:79], 0
    ds_read_b128 v[104:107], v10 offset:8192
    ds_read_b128 v[108:111], v10 offset:12288
    v_mfma_f32_32x32x16_bf16 v[192:207], v[64:67], v[80:83], 0
    v_mfma_f32_32x32x16_bf16 v[208:223], v[68:71], v[80:83], 0
    v_mfma_f32_32x32x16_bf16 v[224:239], v[64:67], v[84:87], 0
    v_mfma_f32_32x32x16_bf16 v[240:255], v[68:71], v[84:87], 0
    s_branch L_g1b_l
L_g1_l:
    s_cmp_eq_u32 s72, s45
    s_cbranch_scc1 L_f1_l
L_f1r_l:
    s_add_u32 s73, s73, 1
    s_cmp_eq_u32 s73, 3
    s_cselect_b32 s75, 4294868992, s74
    s_cselect_b32 s73, 0, s73
    s_waitcnt lgkmcnt(0)
    v_mfma_f32_32x32x16_bf16 v[128:143], v[64:67], v[72:75], v[128:143]
    ds_read_b64_tr_b16 v[88:89], v8 offset:2048
    ds_read_b64_tr_b16 v[90:91], v8 offset:2560
    v_mfma_f32_32x32x16_bf16 v[144:159], v[68:71], v[72:75], v[144:159]
    ds_read_b128 v[96:99], v10
    ds_read_b64_tr_b16 v[92:93], v8 offset:10240
    v_mfma_f32_32x32x16_bf16 v[160:175], v[64:67], v[76:79], v[160:175]
    ds_read_b64_tr_b16 v[94:95], v8 offset:10752
    ds_read_b128 v[100:103], v10 offset:4096
    v_mfma_f32_32x32x16_bf16 v[176:191], v[68:71], v[76:79], v[176:191]
    ds_read_b128 v[104:107], v10 offset:8192
    ds_read_b128 v[108:111], v10 offset:12288
    v_mfma_f32_32x32x16_bf16 v[192:207], v[64:67], v[80:83], v[192:207]
    v_mfma_f32_32x32x16_bf16 v[208:223], v[68:71], v[80:83], v[208:223]
    v_mfma_f32_32x32x16_bf16 v[224:239], v[64:67], v[84:87], v[224:239]
    v_mfma_f32_32x32x16_bf16 v[240:255], v[68:71], v[84:87], v[240:255]
L_g1b_l:
    s_waitcnt lgkmcnt(0)
    v_mfma_f32_32x32x16_bf16 v[128:143], v[88:91], v[96:99], v[128:143]
    ds_read_b64_tr_b16 v[64:65], v8 offset:4096
    ds_read_b64_tr_b16 v[66:67], v8 offset:4608
    v_mfma_f32_32x32x16_bf16 v[144:159], v[92:95], v[96:99], v[144:159]
    ds_read_b128 v[72:75], v11
    ds_read_b64_tr_b16 v[68:69], v8 offset:12288
    v_mfma_f32_32x32x16_bf16 v[160:175], v[88:91], v[100:103], v[160:175]
    ds_read_b64_tr_b16 v[70:71], v8 offset:12800
    ds_read_b128 v[76:79], v11 offset:4096
    v_mfma_f32_32x32x16_bf16 v[176:191], v[92:95], v[100:103], v[176:191]
    ds_read_b128 v[80:83], v11 offset:8192
    ds_read_b128 v[84:87], v11 offset:12288
    v_mfma_f32_32x32x16_bf16 v[192:207], v[88:91], v[104:107], v[192:207]
    v_mfma_f32_32x32x16_bf16 v[208:223], v[92:95], v[104:107], v[208:223]
    v_mfma_f32_32x32x16_bf16 v[224:239], v[88:91], v[108:111], v[224:239]
    v_mfma_f32_32x32x16_bf16 v[240:255], v[92:95], v[108:111], v[240:255]
    s_waitcnt lgkmcnt(0)
    v_mfma_f32_32x32x16_bf16 v[128:143], v[64:67], v[72:75], v[128:143]
    ds_read_b64_tr_b16 v[88:89], v8 offset:6144
    ds_read_b64_tr_b16 v[90:91], v8 offset:6656
    v_mfma_f32_32x32x16_bf16 v[144:159], v[68:71], v[72:75], v[144:159]
    ds_read_b128 v[96:99], v12
    ds_read_b64_tr_b16 v[92:93], v8 offset:14336
    v_mfma_f32_32x32x16_bf16 v[160:175], v[64:67], v[76:79], v[160:175]
    ds_read_b64_tr_b16 v[94:95], v8 offset:14848
    ds_read_b128 v[100:103], v12 offset:4096
    v_mfma_f32_32x32x16_bf16 v[176:191], v[68:71], v[76:79], v[176:191]
    ds_read_b128 v[104:107], v12 offset:8192
    ds_read_b128 v[108:111], v12 offset:12288
    v_mfma_f32_32x32x16_bf16 v[192:207], v[64:67], v[80:83], v[192:207]
    v_add_u32 v8, s75, v8
    v_add_u32 v9, s75, v9
    v_mfma_f32_32x32x16_bf16 v[208:223], v[68:71], v[80:83], v[208:223]
    v_add_u32 v10, s75, v10
    v_add_u32 v11, s75, v11
    v_mfma_f32_32x32x16_bf16 v[224:239], v[64:67], v[84:87], v[224:239]
    v_add_u32 v12, s75, v12
    v_mfma_f32_32x32x16_bf16 v[240:255], v[68:71], v[84:87], v[240:255]
    s_cmp_eq_u32 s72, 9
    s_waitcnt lgkmcnt(0)
    s_cbranch_scc1 L_g1_nbl
    s_barrier
L_g1_nbl:
    v_mfma_f32_32x32x16_bf16 v[128:143], v[88:91], v[96:99], v[128:143]
    ds_read_b64_tr_b16 v[64:65], v8 offset:0
    ds_read_b64_tr_b16 v[66:67], v8 offset:512
    v_mfma_f32_32x32x16_bf16 v[144:159], v[92:95], v[96:99], v[144:159]
    ds_read_b128 v[72:75], v9
    ds_read_b64_tr_b16 v[68:69], v8 offset:8192
    v_mfma_f32_32x32x16_bf16 v[160:175], v[88:91], v[100:103], v[160:175]
    ds_read_b64_tr_b16 v[70:71], v8 offset:8704
    ds_read_b128 v[76:79], v9 offset:4096
    v_mfma_f32_32x32x16_bf16 v[176:191], v[92:95], v[100:103], v[176:191]
    ds_read_b128 v[80:83], v9 offset:8192
    ds_read_b128 v[84:87], v9 offset:12288
    v_mfma_f32_32x32x16_bf16 v[192:207], v[88:91], v[104:107], v[192:207]
    s_add_u32 s72, s72, 1
    s_cmp_lt_u32 s72, 10
    v_mfma_f32_32x32x16_bf16 v[208:223], v[92:95], v[104:107], v[208:223]
    v_mfma_f32_32x32x16_bf16 v[224:239], v[88:91], v[108:111], v[224:239]
    v_mfma_f32_32x32x16_bf16 v[240:255], v[92:95], v[108:111], v[240:255]
    s_cbranch_scc1 L_g1_l
    v_pk_mul_f32 v[128:129], v[128:129], v[144:145]
    v_pk_mul_f32 v[130:131], v[130:131], v[146:147]
    v_pk_mul_f32 v[132:133], v[132:133], v[148:149]
    v_pk_mul_f32 v[134:135], v[134:135], v[150:151]
    v_pk_mul_f32 v[136:137], v[136:137], v[152:153]
    v_pk_mul_f32 v[138:139], v[138:139], v[154:155]
    v_pk_mul_f32 v[140:141], v[140:141], v[156:157]
    v_pk_mul_f32 v[142:143], v[142:143], v[158:159]
    v_cvt_pk_bf16_f32 v24, v128, v129
    v_cvt_pk_bf16_f32 v25, v130, v131
    v_cvt_pk_bf16_f32 v26, v132, v133
    v_cvt_pk_bf16_f32 v27, v134, v135
    v_cvt_pk_bf16_f32 v28, v136, v137
    v_cvt_pk_bf16_f32 v29, v138, v139
    v_cvt_pk_bf16_f32 v30, v140, v141
    v_cvt_pk_bf16_f32 v31, v142, v143
    buffer_store_dwordx4 v[24:27], v16, s[16:19], s76 offen offset:0 sc1
    buffer_store_dwordx4 v[28:31], v16, s[16:19], s76 offen offset:256 sc1
    v_pk_mul_f32 v[160:161], v[160:161], v[176:177]
    v_pk_mul_f32 v[162:163], v[162:163], v[178:179]
    v_pk_mul_f32 v[164:165], v[164:165], v[180:181]
    v_pk_mul_f32 v[166:167], v[166:167], v[182:183]
    v_pk_mul_f32 v[168:169], v[168:169], v[184:185]
    v_pk_mul_f32 v[170:171], v[170:171], v[186:187]
    v_pk_mul_f32 v[172:173], v[172:173], v[188:189]
    v_pk_mul_f32 v[174:175], v[174:175], v[190:191]
    v_cvt_pk_bf16_f32 v32, v160, v161
    v_cvt_pk_bf16_f32 v33, v162, v163
    v_cvt_pk_bf16_f32 v34, v164, v165
    v_cvt_pk_bf16_f32 v35, v166, v167
    v_cvt_pk_bf16_f32 v36, v168, v169
    v_cvt_pk_bf16_f32 v37, v170, v171
    v_cvt_pk_bf16_f32 v38, v172, v173
    v_cvt_pk_bf16_f32 v39, v174, v175
    buffer_store_dwordx4 v[32:35], v16, s[16:19], s77 offen offset:0 sc1
    buffer_store_dwordx4 v[36:39], v16, s[16:19], s77 offen offset:256 sc1
    v_pk_mul_f32 v[192:193], v[192:193], v[208:209]
    v_pk_mul_f32 v[194:195], v[194:195], v[210:211]
    v_pk_mul_f32 v[196:197], v[196:197], v[212:213]
    v_pk_mul_f32 v[198:199], v[198:199], v[214:215]
    v_pk_mul_f32 v[200:201], v[200:201], v[216:217]
    v_pk_mul_f32 v[202:203], v[202:203], v[218:219]
    v_pk_mul_f32 v[204:205], v[204:205], v[220:221]
    v_pk_mul_f32 v[206:207], v[206:207], v[222:223]
    v_cvt_pk_bf16_f32 v40, v192, v193
    v_cvt_pk_bf16_f32 v41, v194, v195
    v_cvt_pk_bf16_f32 v42, v196, v197
    v_cvt_pk_bf16_f32 v43, v198, v199
    v_cvt_pk_bf16_f32 v44, v200, v201
    v_cvt_pk_bf16_f32 v45, v202, v203
    v_cvt_pk_bf16_f32 v46, v204, v205
    v_cvt_pk_bf16_f32 v47, v206, v207
    s_waitcnt lgkmcnt(0)
    s_barrier
    buffer_store_dwordx4 v[40:43], v16, s[16:19], s78 offen offset:0 sc1
    buffer_store_dwordx4 v[44:47], v16, s[16:19], s78 offen offset:256 sc1
    v_pk_mul_f32 v[224:225], v[224:225], v[240:241]
    v_pk_mul_f32 v[226:227], v[226:227], v[242:243]
    v_pk_mul_f32 v[228:229], v[228:229], v[244:245]
    v_pk_mul_f32 v[230:231], v[230:231], v[246:247]
    v_pk_mul_f32 v[232:233], v[232:233], v[248:249]
    v_pk_mul_f32 v[234:235], v[234:235], v[250:251]
    v_pk_mul_f32 v[236:237], v[236:237], v[252:253]
    v_pk_mul_f32 v[238:239], v[238:239], v[254:255]
    v_cvt_pk_bf16_f32 v48, v224, v225
    v_cvt_pk_bf16_f32 v49, v226, v227
    v_cvt_pk_bf16_f32 v50, v228, v229
    v_cvt_pk_bf16_f32 v51, v230, v231
    v_cvt_pk_bf16_f32 v52, v232, v233
    v_cvt_pk_bf16_f32 v53, v234, v235
    v_cvt_pk_bf16_f32 v54, v236, v237
    v_cvt_pk_bf16_f32 v55, v238, v239
    buffer_store_dwordx4 v[48:51], v16, s[16:19], s79 offen offset:0 sc1
    buffer_store_dwordx4 v[52:55], v16, s[16:19], s79 offen offset:256 sc1
    s_lshl_b32 s80, s70, 10
    v_add_u32 v10, s80, v1
    v_xor_b32 v11, 1024, v10
    s_mov_b32 s79, 2146435072
    s_waitcnt vmcnt(0)
    s_mov_b32 s97, 2146435072
    v_lshlrev_b32 v18, 8, v2
    v_mov_b32 v19, 1
    s_mov_b64 exec, 15
    buffer_store_dword v19, v18, s[16:19], s61 offen sc1
    s_mov_b64 exec, -1
    s_barrier
    s_mul_i32 s80, s70, 5120
    v_add_u32 v8, s80, v1
    v_add_u32 v9, 61440, v8
    ds_read_b128 v[104:107], v8 offset:0
    ds_read_b128 v[108:111], v8 offset:1024
    ds_read_b128 v[112:115], v8 offset:2048
    ds_read_b128 v[116:119], v8 offset:3072
    ds_read_b128 v[120:123], v8 offset:4096
    s_mov_b32 s90, 0
L_poll_5:
    buffer_load_dword v18, v13, s[16:19], 0 offen sc1
    s_waitcnt vmcnt(0)
    v_cmp_ne_u32 vcc, 1, v18
    s_nop 0
    s_and_b32 s91, vcc_lo, 0x7ffffff
    s_and_b32 s92, vcc_lo, 0xfff
    s_cbranch_scc0 L_pdone_6
    s_sleep 4
    s_add_u32 s90, s90, 1
    s_cmp_lt_u32 s90, 40000
    s_cbranch_scc1 L_poll_5
L_pdone_6:
    s_add_u32 s80, s64, 0
    buffer_load_dwordx4 v[16:19], v10, s[16:19], s80 offen sc1
    buffer_load_dwordx4 v[20:23], v11, s[16:19], s80 offen sc1
    s_add_u32 s80, s64, 40960
    buffer_load_dwordx4 v[24:27], v10, s[16:19], s80 offen sc1
    buffer_load_dwordx4 v[28:31], v11, s[16:19], s80 offen sc1
    s_add_u32 s80, s64, 81920
    buffer_load_dwordx4 v[32:35], v10, s[16:19], s80 offen sc1
    buffer_load_dwordx4 v[36:39], v11, s[16:19], s80 offen sc1
    s_add_u32 s80, s64, 122880
    buffer_load_dwordx4 v[40:43], v10, s[16:19], s80 offen sc1
    buffer_load_dwordx4 v[44:47], v11, s[16:19], s80 offen sc1
    s_add_u32 s80, s65, 0
    buffer_load_dwordx4 v[48:51], v10, s[16:19], s80 offen sc1
    buffer_load_dwordx4 v[52:55], v11, s[16:19], s80 offen sc1
    s_add_u32 s80, s65, 40960
    buffer_load_dwordx4 v[56:59], v10, s[16:19], s80 offen sc1
    buffer_load_dwordx4 v[60:63], v11, s[16:19], s80 offen sc1
    s_add_u32 s80, s65, 81920
    buffer_load_dwordx4 v[192:195], v10, s[16:19], s80 offen sc1
    buffer_load_dwordx4 v[196:199], v11, s[16:19], s80 offen sc1
L_comp_g2:
    s_lshl_b32 s72, s71, 1
    s_add_u32 s72, s72, s70
    s_lshl_b32 s80, s57, 2
    s_add_u32 s73, s80, s72
    s_lshl_b32 s74, s73, 6
    s_add_u32 s74, s74, 10240
    v_cvt_pk_bf16_f32 v224, v224, v225
    v_cvt_pk_bf16_f32 v225, v226, v227
    v_cvt_pk_bf16_f32 v226, v228, v229
    v_cvt_pk_bf16_f32 v227, v230, v231
    s_nop 0
    v_permlane16_swap_b32 v224, v226
    v_permlane16_swap_b32 v225, v227
    buffer_store_dwordx4 v[224:227], v12, s[16:19], s97 offen offset:0 sc1
    v_cvt_pk_bf16_f32 v232, v232, v233
    v_cvt_pk_bf16_f32 v233, v234, v235
    v_cvt_pk_bf16_f32 v234, v236, v237
    v_cvt_pk_bf16_f32 v235, v238, v239
    s_nop 0
    v_permlane16_swap_b32 v232, v234
    v_permlane16_swap_b32 v233, v235
    buffer_store_dwordx4 v[232:235], v12, s[16:19], s97 offen offset:1024 sc1
    v_cvt_pk_bf16_f32 v240, v240, v241
    v_cvt_pk_bf16_f32 v241, v242, v243
    v_cvt_pk_bf16_f32 v242, v244, v245
    v_cvt_pk_bf16_f32 v243, v246, v247
    s_nop 0
    v_permlane16_swap_b32 v240, v242
    v_permlane16_swap_b32 v241, v243
    buffer_store_dwordx4 v[240:243], v12, s[16:19], s97 offen offset:2048 sc1
    v_cvt_pk_bf16_f32 v248, v248, v249
    v_cvt_pk_bf16_f32 v249, v250, v251
    v_cvt_pk_bf16_f32 v250, v252, v253
    v_cvt_pk_bf16_f32 v251, v254, v255
    s_nop 0
    v_permlane16_swap_b32 v248, v250
    v_permlane16_swap_b32 v249, v251
    buffer_store_dwordx4 v[248:251], v12, s[16:19], s97 offen offset:3072 sc1
    s_waitcnt lgkmcnt(0)
    s_waitcnt vmcnt(16)
    v_mfma_f32_16x16x32_bf16 v[64:67], v[104:107], v[16:19], 0
    ds_read_b128 v[124:127], v8 offset:10240
    v_mfma_f32_16x16x32_bf16 v[84:87], v[104:107], v[20:23], 0
    ds_read_b128 v[128:131], v8 offset:11264
    v_mfma_f32_16x16x32_bf16 v[68:71], v[108:111], v[16:19], 0
    ds_read_b128 v[132:135], v8 offset:12288
    v_mfma_f32_16x16x32_bf16 v[88:91], v[108:111], v[20:23], 0
    ds_read_b128 v[136:139], v8 offset:13312
    v_mfma_f32_16x16x32_bf16 v[72:75], v[112:115], v[16:19], 0
    ds_read_b128 v[140:143], v8 offset:14336
    v_mfma_f32_16x16x32_bf16 v[92:95], v[112:115], v[20:23], 0
    s_add_u32 s80, s65, 122880
    v_mfma_f32_16x16x32_bf16 v[76:79], v[116:119], v[16:19], 0
    buffer_load_dwordx4 v[200:203], v10, s[16:19], s80 offen sc1
    v_mfma_f32_16x16x32_bf16 v[96:99], v[116:119], v[20:23], 0
    v_mfma_f32_16x16x32_bf16 v[80:83], v[120:123], v[16:19], 0
    buffer_load_dwordx4 v[204:207], v11, s[16:19], s80 offen sc1
    v_mfma_f32_16x16x32_bf16 v[100:103], v[120:123], v[20:23], 0
    s_waitcnt lgkmcnt(3)
    s_waitcnt vmcnt(16)
    v_mfma_f32_16x16x32_bf16 v[64:67], v[124:127], v[24:27], v[64:67]
    ds_read_b128 v[104:107], v8 offset:20480
    v_mfma_f32_16x16x32_bf16 v[84:87], v[124:127], v[28:31], v[84:87]
    ds_read_b128 v[108:111], v8 offset:21504
    v_mfma_f32_16x16x32_bf16 v[68:71], v[128:131], v[24:27], v[68:71]
    ds_read_b128 v[112:115], v8 offset:22528
    v_mfma_f32_16x16x32_bf16 v[88:91], v[128:131], v[28:31], v[88:91]
    ds_read_b128 v[116:119], v8 offset:23552
    s_waitcnt lgkmcnt(4)
    v_mfma_f32_16x16x32_bf16 v[72:75], v[132:135], v[24:27], v[72:75]
    ds_read_b128 v[120:123], v8 offset:24576
    v_mfma_f32_16x16x32_bf16 v[92:95], v[132:135], v[28:31], v[92:95]
    s_add_u32 s80, s66, 0
    v_mfma_f32_16x16x32_bf16 v[76:79], v[136:139], v[24:27], v[76:79]
    buffer_load_dwordx4 v[208:211], v10, s[16:19], s80 offen sc1
    v_mfma_f32_16x16x32_bf16 v[96:99], v[136:139], v[28:31], v[96:99]
    v_mfma_f32_16x16x32_bf16 v[80:83], v[140:143], v[24:27], v[80:83]
    buffer_load_dwordx4 v[212:215], v11, s[16:19], s80 offen sc1
    v_mfma_f32_16x16x32_bf16 v[100:103], v[140:143], v[28:31], v[100:103]
    s_waitcnt lgkmcnt(3)
    s_waitcnt vmcnt(16)
    v_mfma_f32_16x16x32_bf16 v[64:67], v[104:107], v[32:35], v[64:67]
    ds_read_b128 v[124:127], v8 offset:30720
    v_mfma_f32_16x16x32_bf16 v[84:87], v[104:107], v[36:39], v[84:87]
    ds_read_b128 v[128:131], v8 offset:31744
    v_mfma_f32_16x16x32_bf16 v[68:71], v[108:111], v[32:35], v[68:71]
    ds_read_b128 v[132:135], v8 offset:32768
    v_mfma_f32_16x16x32_bf16 v[88:91], v[108:111], v[36:39], v[88:91]
    ds_read_b128 v[136:139], v8 offset:33792
    s_waitcnt lgkmcnt(4)
    v_mfma_f32_16x16x32_bf16 v[72:75], v[112:115], v[32:35], v[72:75]
    ds_read_b128 v[140:143], v8 offset:34816
    v_mfma_f32_16x16x32_bf16 v[92:95], v[112:115], v[36:39], v[92:95]
    s_add_u32 s80, s66, 40960
    v_mfma_f32_16x16x32_bf16 v[76:79], v[116:119], v[32:35], v[76:79]
    buffer_load_dwordx4 v[216:219], v10, s[16:19], s80 offen sc1
    v_mfma_f32_16x16x32_bf16 v[96:99], v[116:119], v[36:39], v[96:99]
    v_mfma_f32_16x16x32_bf16 v[80:83], v[120:123], v[32:35], v[80:83]
    buffer_load_dwordx4 v[220:223], v11, s[16:19], s80 offen sc1
    v_mfma_f32_16x16x32_bf16 v[100:103], v[120:123], v[36:39], v[100:103]
    s_waitcnt lgkmcnt(3)
    s_waitcnt vmcnt(16)
    v_mfma_f32_16x16x32_bf16 v[64:67], v[124:127], v[40:43], v[64:67]
    ds_read_b128 v[104:107], v8 offset:40960
    v_mfma_f32_16x16x32_bf16 v[84:87], v[124:127], v[44:47], v[84:87]
    ds_read_b128 v[108:111], v8 offset:41984
    v_mfma_f32_16x16x32_bf16 v[68:71], v[128:131], v[40:43], v[68:71]
    ds_read_b128 v[112:115], v8 offset:43008
    v_mfma_f32_16x16x32_bf16 v[88:91], v[128:131], v[44:47], v[88:91]
    ds_read_b128 v[116:119], v8 offset:44032
    s_waitcnt lgkmcnt(4)
    v_mfma_f32_16x16x32_bf16 v[72:75], v[132:135], v[40:43], v[72:75]
    ds_read_b128 v[120:123], v8 offset:45056
    v_mfma_f32_16x16x32_bf16 v[92:95], v[132:135], v[44:47], v[92:95]
    s_add_u32 s80, s66, 81920
    v_mfma_f32_16x16x32_bf16 v[76:79], v[136:139], v[40:43], v[76:79]
    buffer_load_dwordx4 v[144:147], v10, s[16:19], s80 offen sc1
    v_mfma_f32_16x16x32_bf16 v[96:99], v[136:139], v[44:47], v[96:99]
    v_mfma_f32_16x16x32_bf16 v[80:83], v[140:143], v[40:43], v[80:83]
    buffer_load_dwordx4 v[148:151], v11, s[16:19], s80 offen sc1
    v_mfma_f32_16x16x32_bf16 v[100:103], v[140:143], v[44:47], v[100:103]
    s_waitcnt lgkmcnt(3)
    s_waitcnt vmcnt(16)
    v_mfma_f32_16x16x32_bf16 v[64:67], v[104:107], v[48:51], v[64:67]
    ds_read_b128 v[124:127], v8 offset:51200
    v_mfma_f32_16x16x32_bf16 v[84:87], v[104:107], v[52:55], v[84:87]
    ds_read_b128 v[128:131], v8 offset:52224
    v_mfma_f32_16x16x32_bf16 v[68:71], v[108:111], v[48:51], v[68:71]
    ds_read_b128 v[132:135], v8 offset:53248
    v_mfma_f32_16x16x32_bf16 v[88:91], v[108:111], v[52:55], v[88:91]
    ds_read_b128 v[136:139], v8 offset:54272
    s_waitcnt lgkmcnt(4)
    v_mfma_f32_16x16x32_bf16 v[72:75], v[112:115], v[48:51], v[72:75]
    ds_read_b128 v[140:143], v8 offset:55296
    v_mfma_f32_16x16x32_bf16 v[92:95], v[112:115], v[52:55], v[92:95]
    s_add_u32 s80, s66, 122880
    v_mfma_f32_16x16x32_bf16 v[76:79], v[116:119], v[48:51], v[76:79]
    buffer_load_dwordx4 v[152:155], v10, s[16:19], s80 offen sc1
    v_mfma_f32_16x16x32_bf16 v[96:99], v[116:119], v[52:55], v[96:99]
    v_mfma_f32_16x16x32_bf16 v[80:83], v[120:123], v[48:51], v[80:83]
    buffer_load_dwordx4 v[156:159], v11, s[16:19], s80 offen sc1
    v_mfma_f32_16x16x32_bf16 v[100:103], v[120:123], v[52:55], v[100:103]
    s_waitcnt lgkmcnt(0)
    s_barrier
    s_cmp_eq_u32 s91, 0
    s_cbranch_scc1 L_g2_all
    s_mov_b32 s90, 0
L_poll_7:
    buffer_load_dword v6, v13, s[16:19], 0 offen sc1
    s_waitcnt vmcnt(0)
    v_cmp_ne_u32 vcc, 1, v6
    s_nop 0
    s_and_b32 s92, vcc_lo, 0x7ffffff
    s_cbranch_scc0 L_pdone_8
    s_sleep 4
    s_add_u32 s90, s90, 1
    s_cmp_lt_u32 s90, 40000
    s_cbranch_scc1 L_poll_7
L_pdone_8:
L_g2_all:
    s_waitcnt vmcnt(16)
    v_mfma_f32_16x16x32_bf16 v[64:67], v[124:127], v[56:59], v[64:67]
    ds_read_b128 v[104:107], v9 offset:0
    v_mfma_f32_16x16x32_bf16 v[84:87], v[124:127], v[60:63], v[84:87]
    ds_read_b128 v[108:111], v9 offset:1024
    v_mfma_f32_16x16x32_bf16 v[68:71], v[128:131], v[56:59], v[68:71]
    ds_read_b128 v[112:115], v9 offset:2048
    v_mfma_f32_16x16x32_bf16 v[88:91], v[128:131], v[60:63], v[88:91]
    ds_read_b128 v[116:119], v9 offset:3072
    v_mfma_f32_16x16x32_bf16 v[72:75], v[132:135], v[56:59], v[72:75]
    ds_read_b128 v[120:123], v9 offset:4096
    v_mfma_f32_16x16x32_bf16 v[92:95], v[132:135], v[60:63], v[92:95]
    s_add_u32 s80, s67, 0
    v_mfma_f32_16x16x32_bf16 v[76:79], v[136:139], v[56:59], v[76:79]
    buffer_load_dwordx4 v[160:163], v10, s[16:19], s80 offen sc1
    v_mfma_f32_16x16x32_bf16 v[96:99], v[136:139], v[60:63], v[96:99]
    v_mfma_f32_16x16x32_bf16 v[80:83], v[140:143], v[56:59], v[80:83]
    buffer_load_dwordx4 v[164:167], v11, s[16:19], s80 offen sc1
    v_mfma_f32_16x16x32_bf16 v[100:103], v[140:143], v[60:63], v[100:103]
    s_waitcnt lgkmcnt(3)
    s_waitcnt vmcnt(12)
    v_mov_b32 v12, 0
    v_mov_b32 v15, 1
    s_mov_b64 exec, 1
    buffer_store_dword v15, v12, s[16:19], s79 offen sc1
    s_mov_b64 exec, -1
    v_mfma_f32_16x16x32_bf16 v[64:67], v[104:107], v[192:195], v[64:67]
    ds_read_b128 v[124:127], v9 offset:10240
    v_mfma_f32_16x16x32_bf16 v[84:87], v[104:107], v[196:199], v[84:87]
    ds_read_b128 v[128:131], v9 offset:11264
    v_mfma_f32_16x16x32_bf16 v[68:71], v[108:111], v[192:195], v[68:71]
    ds_read_b128 v[132:135], v9 offset:12288
    v_mfma_f32_16x16x32_bf16 v[88:91], v[108:111], v[196:199], v[88:91]
    ds_read_b128 v[136:139], v9 offset:13312
    s_waitcnt lgkmcnt(4)
    v_mfma_f32_16x16x32_bf16 v[72:75], v[112:115], v[192:195], v[72:75]
    ds_read_b128 v[140:143], v9 offset:14336
    v_mfma_f32_16x16x32_bf16 v[92:95], v[112:115], v[196:199], v[92:95]
    s_add_u32 s80, s67, 40960
    v_mfma_f32_16x16x32_bf16 v[76:79], v[116:119], v[192:195], v[76:79]
    buffer_load_dwordx4 v[168:171], v10, s[16:19], s80 offen sc1
    v_mfma_f32_16x16x32_bf16 v[96:99], v[116:119], v[196:199], v[96:99]
    v_add_u32 v13, 122880, v8
    v_mfma_f32_16x16x32_bf16 v[80:83], v[120:123], v[192:195], v[80:83]
    buffer_load_dwordx4 v[172:175], v11, s[16:19], s80 offen sc1
    v_mfma_f32_16x16x32_bf16 v[100:103], v[120:123], v[196:199], v[100:103]
    s_waitcnt lgkmcnt(3)
    s_waitcnt vmcnt(13)
    v_mfma_f32_16x16x32_bf16 v[64:67], v[124:127], v[200:203], v[64:67]
    ds_read_b128 v[104:107], v9 offset:20480
    v_mfma_f32_16x16x32_bf16 v[84:87], v[124:127], v[204:207], v[84:87]
    ds_read_b128 v[108:111], v9 offset:21504
    v_mfma_f32_16x16x32_bf16 v[68:71], v[128:131], v[200:203], v[68:71]
    ds_read_b128 v[112:115], v9 offset:22528
    v_mfma_f32_16x16x32_bf16 v[88:91], v[128:131], v[204:207], v[88:91]
    ds_read_b128 v[116:119], v9 offset:23552
    s_waitcnt lgkmcnt(4)
    v_mfma_f32_16x16x32_bf16 v[72:75], v[132:135], v[200:203], v[72:75]
    ds_read_b128 v[120:123], v9 offset:24576
    v_mfma_f32_16x16x32_bf16 v[92:95], v[132:135], v[204:207], v[92:95]
    s_add_u32 s80, s67, 81920
    v_and_b32 v14, 15, v2
    v_mfma_f32_16x16x32_bf16 v[76:79], v[136:139], v[200:203], v[76:79]
    buffer_load_dwordx4 v[176:179], v10, s[16:19], s80 offen sc1
    v_mfma_f32_16x16x32_bf16 v[96:99], v[136:139], v[204:207], v[96:99]
    v_lshlrev_b32 v14, 2, v14
    v_mfma_f32_16x16x32_bf16 v[80:83], v[140:143], v[200:203], v[80:83]
    buffer_load_dwordx4 v[180:183], v11, s[16:19], s80 offen sc1
    v_mfma_f32_16x16x32_bf16 v[100:103], v[140:143], v[204:207], v[100:103]
    s_mul_i32 s81, s3, 5120
    s_waitcnt lgkmcnt(3)
    s_waitcnt vmcnt(13)
    v_mfma_f32_16x16x32_bf16 v[64:67], v[104:107], v[208:211], v[64:67]
    ds_read_b128 v[124:127], v9 offset:30720
    v_mfma_f32_16x16x32_bf16 v[84:87], v[104:107], v[212:215], v[84:87]
    ds_read_b128 v[128:131], v9 offset:31744
    v_mfma_f32_16x16x32_bf16 v[68:71], v[108:111], v[208:211], v[68:71]
    ds_read_b128 v[132:135], v9 offset:32768
    v_mfma_f32_16x16x32_bf16 v[88:91], v[108:111], v[212:215], v[88:91]
    ds_read_b128 v[136:139], v9 offset:33792
    s_waitcnt lgkmcnt(4)
    v_mfma_f32_16x16x32_bf16 v[72:75], v[112:115], v[208:211], v[72:75]
    ds_read_b128 v[140:143], v9 offset:34816
    v_mfma_f32_16x16x32_bf16 v[92:95], v[112:115], v[212:215], v[92:95]
    s_add_u32 s80, s67, 122880
    s_add_u32 s81, s81, 143360
    v_mfma_f32_16x16x32_bf16 v[76:79], v[116:119], v[208:211], v[76:79]
    buffer_load_dwordx4 v[184:187], v10, s[16:19], s80 offen sc1
    v_mfma_f32_16x16x32_bf16 v[96:99], v[116:119], v[212:215], v[96:99]
    v_add_u32 v12, s81, v1
    v_mfma_f32_16x16x32_bf16 v[80:83], v[120:123], v[208:211], v[80:83]
    buffer_load_dwordx4 v[188:191], v11, s[16:19], s80 offen sc1
    v_mfma_f32_16x16x32_bf16 v[100:103], v[120:123], v[212:215], v[100:103]
    v_lshrrev_b32 v4, 4, v2
    s_waitcnt lgkmcnt(3)
    s_waitcnt vmcnt(13)
    v_mfma_f32_16x16x32_bf16 v[64:67], v[124:127], v[216:219], v[64:67]
    ds_read_b128 v[104:107], v9 offset:40960
    v_mfma_f32_16x16x32_bf16 v[84:87], v[124:127], v[220:223], v[84:87]
    ds_read_b128 v[108:111], v9 offset:41984
    v_mfma_f32_16x16x32_bf16 v[68:71], v[128:131], v[216:219], v[68:71]
    ds_read_b128 v[112:115], v9 offset:43008
    v_mfma_f32_16x16x32_bf16 v[88:91], v[128:131], v[220:223], v[88:91]
    ds_read_b128 v[116:119], v9 offset:44032
    s_waitcnt lgkmcnt(4)
    v_mfma_f32_16x16x32_bf16 v[72:75], v[132:135], v[216:219], v[72:75]
    ds_read_b128 v[120:123], v9 offset:45056
    v_mfma_f32_16x16x32_bf16 v[92:95], v[132:135], v[220:223], v[92:95]
    s_add_u32 s80, s68, 0
    v_lshlrev_b32 v5, 2, v4
    v_mfma_f32_16x16x32_bf16 v[76:79], v[136:139], v[216:219], v[76:79]
    buffer_load_dwordx4 v[224:227], v10, s[16:19], s80 offen sc1
    v_mfma_f32_16x16x32_bf16 v[96:99], v[136:139], v[220:223], v[96:99]
    v_bfe_u32 v6, v2, 2, 2
    v_mfma_f32_16x16x32_bf16 v[80:83], v[140:143], v[216:219], v[80:83]
    buffer_load_dwordx4 v[228:231], v11, s[16:19], s80 offen sc1
    v_mfma_f32_16x16x32_bf16 v[100:103], v[140:143], v[220:223], v[100:103]
    v_add_u32 v5, v5, v6
    s_waitcnt lgkmcnt(3)
    s_waitcnt vmcnt(13)
    v_mfma_f32_16x16x32_bf16 v[64:67], v[104:107], v[144:147], v[64:67]
    ds_read_b128 v[124:127], v9 offset:51200
    v_mfma_f32_16x16x32_bf16 v[84:87], v[104:107], v[148:151], v[84:87]
    ds_read_b128 v[128:131], v9 offset:52224
    v_mfma_f32_16x16x32_bf16 v[68:71], v[108:111], v[144:147], v[68:71]
    ds_read_b128 v[132:135], v9 offset:53248
    v_mfma_f32_16x16x32_bf16 v[88:91], v[108:111], v[148:151], v[88:91]
    ds_read_b128 v[136:139], v9 offset:54272
    s_waitcnt lgkmcnt(4)
    v_mfma_f32_16x16x32_bf16 v[72:75], v[112:115], v[144:147], v[72:75]
    ds_read_b128 v[140:143], v9 offset:55296
    v_mfma_f32_16x16x32_bf16 v[92:95], v[112:115], v[148:151], v[92:95]
    s_add_u32 s80, s68, 40960
    v_lshlrev_b32 v5, 7, v5
    v_mfma_f32_16x16x32_bf16 v[76:79], v[116:119], v[144:147], v[76:79]
    buffer_load_dwordx4 v[232:235], v10, s[16:19], s80 offen sc1
    v_mfma_f32_16x16x32_bf16 v[96:99], v[116:119], v[148:151], v[96:99]
    v_and_b32 v6, 3, v2
    v_mfma_f32_16x16x32_bf16 v[80:83], v[120:123], v[144:147], v[80:83]
    buffer_load_dwordx4 v[236:239], v11, s[16:19], s80 offen sc1
    v_mfma_f32_16x16x32_bf16 v[100:103], v[120:123], v[148:151], v[100:103]
    v_lshlrev_b32 v6, 3, v6
    s_waitcnt lgkmcnt(0)
    s_barrier
    s_waitcnt vmcnt(13)
    v_mfma_f32_16x16x32_bf16 v[64:67], v[124:127], v[152:155], v[64:67]
    ds_read_b128 v[104:107], v13 offset:0
    v_mfma_f32_16x16x32_bf16 v[84:87], v[124:127], v[156:159], v[84:87]
    ds_read_b128 v[108:111], v13 offset:1024
    v_mfma_f32_16x16x32_bf16 v[68:71], v[128:131], v[152:155], v[68:71]
    ds_read_b128 v[112:115], v13 offset:2048
    v_mfma_f32_16x16x32_bf16 v[88:91], v[128:131], v[156:159], v[88:91]
    ds_read_b128 v[116:119], v13 offset:3072
    v_mfma_f32_16x16x32_bf16 v[72:75], v[132:135], v[152:155], v[72:75]
    ds_read_b128 v[120:123], v13 offset:4096
    v_mfma_f32_16x16x32_bf16 v[92:95], v[132:135], v[156:159], v[92:95]
    s_add_u32 s80, s68, 81920
    s_lshl_b32 s81, s72, 5
    v_mfma_f32_16x16x32_bf16 v[76:79], v[136:139], v[152:155], v[76:79]
    buffer_load_dwordx4 v[240:243], v10, s[16:19], s80 offen sc1
    v_mfma_f32_16x16x32_bf16 v[96:99], v[136:139], v[156:159], v[96:99]
    s_add_u32 s81, s81, 112640
    v_mfma_f32_16x16x32_bf16 v[80:83], v[140:143], v[152:155], v[80:83]
    buffer_load_dwordx4 v[244:247], v11, s[16:19], s80 offen sc1
    v_mfma_f32_16x16x32_bf16 v[100:103], v[140:143], v[156:159], v[100:103]
    v_add3_u32 v3, v5, v6, s81
    s_waitcnt lgkmcnt(3)
    s_waitcnt vmcnt(13)
    v_mfma_f32_16x16x32_bf16 v[64:67], v[104:107], v[160:163], v[64:67]
    ds_read_b128 v[124:127], v13 offset:10240
    v_mfma_f32_16x16x32_bf16 v[84:87], v[104:107], v[164:167], v[84:87]
    ds_read_b128 v[128:131], v13 offset:11264
    v_mfma_f32_16x16x32_bf16 v[68:71], v[108:111], v[160:163], v[68:71]
    ds_read_b128 v[132:135], v13 offset:12288
    v_mfma_f32_16x16x32_bf16 v[88:91], v[108:111], v[164:167], v[88:91]
    ds_read_b128 v[136:139], v13 offset:13312
    s_waitcnt lgkmcnt(4)
    v_mfma_f32_16x16x32_bf16 v[72:75], v[112:115], v[160:163], v[72:75]
    ds_read_b128 v[140:143], v13 offset:14336
    v_mfma_f32_16x16x32_bf16 v[92:95], v[112:115], v[164:167], v[92:95]
    s_add_u32 s80, s68, 122880
    v_and_b32 v5, 15, v2
    v_mfma_f32_16x16x32_bf16 v[76:79], v[116:119], v[160:163], v[76:79]
    buffer_load_dwordx4 v[248:251], v10, s[16:19], s80 offen sc1
    v_mfma_f32_16x16x32_bf16 v[96:99], v[116:119], v[164:167], v[96:99]
    v_mul_u32_u24 v5, 1280, v5
    v_mfma_f32_16x16x32_bf16 v[80:83], v[120:123], v[160:163], v[80:83]
    buffer_load_dwordx4 v[252:255], v11, s[16:19], s80 offen sc1
    v_mfma_f32_16x16x32_bf16 v[100:103], v[120:123], v[164:167], v[100:103]
    v_lshl_add_u32 v4, v4, 3, v5
    s_waitcnt lgkmcnt(3)
    s_waitcnt vmcnt(12)
    v_mfma_f32_16x16x32_bf16 v[64:67], v[124:127], v[168:171], v[64:67]
    ds_read_b128 v[104:107], v13 offset:20480
    v_mfma_f32_16x16x32_bf16 v[84:87], v[124:127], v[172:175], v[84:87]
    ds_read_b128 v[108:111], v13 offset:21504
    v_mfma_f32_16x16x32_bf16 v[68:71], v[128:131], v[168:171], v[68:71]
    ds_read_b128 v[112:115], v13 offset:22528
    v_mfma_f32_16x16x32_bf16 v[88:91], v[128:131], v[172:175], v[88:91]
    ds_read_b128 v[116:119], v13 offset:23552
    s_waitcnt lgkmcnt(4)
    v_mfma_f32_16x16x32_bf16 v[72:75], v[132:135], v[168:171], v[72:75]
    ds_read_b128 v[120:123], v13 offset:24576
    v_mfma_f32_16x16x32_bf16 v[92:95], v[132:135], v[172:175], v[92:95]
    s_add_u32 s80, s69, 163840
    v_bfe_u32 v6, v2, 4, 1
    v_mfma_f32_16x16x32_bf16 v[76:79], v[136:139], v[168:171], v[76:79]
    buffer_load_dwordx4 v[16:19], v10, s[16:19], s80 offen sc1
    v_mfma_f32_16x16x32_bf16 v[96:99], v[136:139], v[172:175], v[96:99]
    v_lshl_add_u32 v5, v6, 5, v5
    v_mfma_f32_16x16x32_bf16 v[80:83], v[140:143], v[168:171], v[80:83]
    buffer_load_dwordx4 v[20:23], v11, s[16:19], s80 offen sc1
    v_mfma_f32_16x16x32_bf16 v[100:103], v[140:143], v[172:175], v[100:103]
    v_lshrrev_b32 v6, 5, v2
    s_waitcnt lgkmcnt(3)
    s_waitcnt vmcnt(12)
    v_mfma_f32_16x16x32_bf16 v[64:67], v[104:107], v[176:179], v[64:67]
    ds_read_b128 v[124:127], v13 offset:30720
    v_mfma_f32_16x16x32_bf16 v[84:87], v[104:107], v[180:183], v[84:87]
    ds_read_b128 v[128:131], v13 offset:31744
    v_mfma_f32_16x16x32_bf16 v[68:71], v[108:111], v[176:179], v[68:71]
    ds_read_b128 v[132:135], v13 offset:32768
    v_mfma_f32_16x16x32_bf16 v[88:91], v[108:111], v[180:183], v[88:91]
    ds_read_b128 v[136:139], v13 offset:33792
    s_waitcnt lgkmcnt(4)
    v_mfma_f32_16x16x32_bf16 v[72:75], v[112:115], v[176:179], v[72:75]
    ds_read_b128 v[140:143], v13 offset:34816
    v_mfma_f32_16x16x32_bf16 v[92:95], v[112:115], v[180:183], v[92:95]
    s_add_u32 s80, s69, 172032
    v_lshl_add_u32 v5, v6, 4, v5
    v_mfma_f32_16x16x32_bf16 v[76:79], v[116:119], v[176:179], v[76:79]
    buffer_load_dwordx4 v[24:27], v10, s[16:19], s80 offen sc1
    v_mfma_f32_16x16x32_bf16 v[96:99], v[116:119], v[180:183], v[96:99]
    s_mul_i32 s75, s73, 20480
    v_mfma_f32_16x16x32_bf16 v[80:83], v[120:123], v[176:179], v[80:83]
    buffer_load_dwordx4 v[28:31], v11, s[16:19], s80 offen sc1
    v_mfma_f32_16x16x32_bf16 v[100:103], v[120:123], v[180:183], v[100:103]
    s_mul_i32 s81, s58, 160
    s_waitcnt lgkmcnt(3)
    s_waitcnt vmcnt(12)
    v_mfma_f32_16x16x32_bf16 v[64:67], v[124:127], v[184:187], v[64:67]
    ds_read_b128 v[104:107], v8 offset:0
    v_mfma_f32_16x16x32_bf16 v[84:87], v[124:127], v[188:191], v[84:87]
    ds_read_b128 v[108:111], v8 offset:1024
    v_mfma_f32_16x16x32_bf16 v[68:71], v[128:131], v[184:187], v[68:71]
    ds_read_b128 v[112:115], v8 offset:2048
    v_mfma_f32_16x16x32_bf16 v[88:91], v[128:131], v[188:191], v[88:91]
    ds_read_b128 v[116:119], v8 offset:3072
    s_waitcnt lgkmcnt(4)
    v_mfma_f32_16x16x32_bf16 v[72:75], v[132:135], v[184:187], v[72:75]
    ds_read_b128 v[120:123], v8 offset:4096
    v_mfma_f32_16x16x32_bf16 v[92:95], v[132:135], v[188:191], v[92:95]
    s_add_u32 s80, s69, 180224
    s_add_u32 s75, s75, s81
    v_mfma_f32_16x16x32_bf16 v[76:79], v[136:139], v[184:187], v[76:79]
    buffer_load_dwordx4 v[32:35], v10, s[16:19], s80 offen sc1
    v_mfma_f32_16x16x32_bf16 v[96:99], v[136:139], v[188:191], v[96:99]
    v_mfma_f32_16x16x32_bf16 v[80:83], v[140:143], v[184:187], v[80:83]
    buffer_load_dwordx4 v[36:39], v11, s[16:19], s80 offen sc1
    v_mfma_f32_16x16x32_bf16 v[100:103], v[140:143], v[188:191], v[100:103]
    s_waitcnt lgkmcnt(3)
    s_waitcnt vmcnt(12)
    v_mfma_f32_16x16x32_bf16 v[64:67], v[104:107], v[224:227], v[64:67]
    ds_read_b128 v[124:127], v8 offset:10240
    v_mfma_f32_16x16x32_bf16 v[84:87], v[104:107], v[228:231], v[84:87]
    ds_read_b128 v[128:131], v8 offset:11264
    v_mfma_f32_16x16x32_bf16 v[68:71], v[108:111], v[224:227], v[68:71]
    ds_read_b128 v[132:135], v8 offset:12288
    v_mfma_f32_16x16x32_bf16 v[88:91], v[108:111], v[228:231], v[88:91]
    ds_read_b128 v[136:139], v8 offset:13312
    s_waitcnt lgkmcnt(4)
    v_mfma_f32_16x16x32_bf16 v[72:75], v[112:115], v[224:227], v[72:75]
    ds_read_b128 v[140:143], v8 offset:14336
    v_mfma_f32_16x16x32_bf16 v[92:95], v[112:115], v[228:231], v[92:95]
    s_add_u32 s80, s69, 188416
    v_mfma_f32_16x16x32_bf16 v[76:79], v[116:119], v[224:227], v[76:79]
    buffer_load_dwordx4 v[40:43], v10, s[16:19], s80 offen sc1
    v_mfma_f32_16x16x32_bf16 v[96:99], v[116:119], v[228:231], v[96:99]
    v_mfma_f32_16x16x32_bf16 v[80:83], v[120:123], v[224:227], v[80:83]
    buffer_load_dwordx4 v[44:47], v11, s[16:19], s80 offen sc1
    v_mfma_f32_16x16x32_bf16 v[100:103], v[120:123], v[228:231], v[100:103]
    s_waitcnt lgkmcnt(3)
    s_waitcnt vmcnt(12)
    v_mfma_f32_16x16x32_bf16 v[64:67], v[124:127], v[232:235], v[64:67]
    ds_read_b128 v[104:107], v8 offset:20480
    v_mfma_f32_16x16x32_bf16 v[84:87], v[124:127], v[236:239], v[84:87]
    ds_read_b128 v[108:111], v8 offset:21504
    v_mfma_f32_16x16x32_bf16 v[68:71], v[128:131], v[232:235], v[68:71]
    ds_read_b128 v[112:115], v8 offset:22528
    v_mfma_f32_16x16x32_bf16 v[88:91], v[128:131], v[236:239], v[88:91]
    ds_read_b128 v[116:119], v8 offset:23552
    s_waitcnt lgkmcnt(4)
    v_mfma_f32_16x16x32_bf16 v[72:75], v[132:135], v[232:235], v[72:75]
    ds_read_b128 v[120:123], v8 offset:24576
    v_mfma_f32_16x16x32_bf16 v[92:95], v[132:135], v[236:239], v[92:95]
    s_add_u32 s80, s69, 196608
    v_mfma_f32_16x16x32_bf16 v[76:79], v[136:139], v[232:235], v[76:79]
    buffer_load_dwordx4 v[48:51], v10, s[16:19], s80 offen sc1
    v_mfma_f32_16x16x32_bf16 v[96:99], v[136:139], v[236:239], v[96:99]
    v_mfma_f32_16x16x32_bf16 v[80:83], v[140:143], v[232:235], v[80:83]
    buffer_load_dwordx4 v[52:55], v11, s[16:19], s80 offen sc1
    v_mfma_f32_16x16x32_bf16 v[100:103], v[140:143], v[236:239], v[100:103]
    s_waitcnt lgkmcnt(3)
    s_waitcnt vmcnt(12)
    v_mfma_f32_16x16x32_bf16 v[64:67], v[104:107], v[240:243], v[64:67]
    ds_read_b128 v[124:127], v8 offset:30720
    v_mfma_f32_16x16x32_bf16 v[84:87], v[104:107], v[244:247], v[84:87]
    ds_read_b128 v[128:131], v8 offset:31744
    v_mfma_f32_16x16x32_bf16 v[68:71], v[108:111], v[240:243], v[68:71]
    ds_read_b128 v[132:135], v8 offset:32768
    v_mfma_f32_16x16x32_bf16 v[88:91], v[108:111], v[244:247], v[88:91]
    ds_read_b128 v[136:139], v8 offset:33792
    s_waitcnt lgkmcnt(4)
    v_mfma_f32_16x16x32_bf16 v[72:75], v[112:115], v[240:243], v[72:75]
    ds_read_b128 v[140:143], v8 offset:34816
    v_mfma_f32_16x16x32_bf16 v[92:95], v[112:115], v[244:247], v[92:95]
    s_add_u32 s80, s69, 204800
    v_mfma_f32_16x16x32_bf16 v[76:79], v[116:119], v[240:243], v[76:79]
    buffer_load_dwordx4 v[56:59], v10, s[16:19], s80 offen sc1
    v_mfma_f32_16x16x32_bf16 v[96:99], v[116:119], v[244:247], v[96:99]
    v_mfma_f32_16x16x32_bf16 v[80:83], v[120:123], v[240:243], v[80:83]
    buffer_load_dwordx4 v[60:63], v11, s[16:19], s80 offen sc1
    v_mfma_f32_16x16x32_bf16 v[100:103], v[120:123], v[244:247], v[100:103]
    s_waitcnt lgkmcnt(3)
    s_waitcnt vmcnt(12)
    v_mfma_f32_16x16x32_bf16 v[64:67], v[124:127], v[248:251], v[64:67]
    ds_read_b128 v[104:107], v8 offset:40960
    v_mfma_f32_16x16x32_bf16 v[84:87], v[124:127], v[252:255], v[84:87]
    ds_read_b128 v[108:111], v8 offset:41984
    v_mfma_f32_16x16x32_bf16 v[68:71], v[128:131], v[248:251], v[68:71]
    ds_read_b128 v[112:115], v8 offset:43008
    v_mfma_f32_16x16x32_bf16 v[88:91], v[128:131], v[252:255], v[88:91]
    ds_read_b128 v[116:119], v8 offset:44032
    s_waitcnt lgkmcnt(4)
    v_mfma_f32_16x16x32_bf16 v[72:75], v[132:135], v[248:251], v[72:75]
    ds_read_b128 v[120:123], v8 offset:45056
    v_mfma_f32_16x16x32_bf16 v[92:95], v[132:135], v[252:255], v[92:95]
    s_add_u32 s80, s69, 212992
    v_mfma_f32_16x16x32_bf16 v[76:79], v[136:139], v[248:251], v[76:79]
    buffer_load_dwordx4 v[192:195], v10, s[16:19], s80 offen sc1
    v_mfma_f32_16x16x32_bf16 v[96:99], v[136:139], v[252:255], v[96:99]
    v_mfma_f32_16x16x32_bf16 v[80:83], v[140:143], v[248:251], v[80:83]
    buffer_load_dwordx4 v[196:199], v11, s[16:19], s80 offen sc1
    v_mfma_f32_16x16x32_bf16 v[100:103], v[140:143], v[252:255], v[100:103]
    s_waitcnt lgkmcnt(3)
    s_waitcnt vmcnt(12)
    v_mfma_f32_16x16x32_bf16 v[64:67], v[104:107], v[16:19], v[64:67]
    ds_read_b128 v[124:127], v8 offset:51200
    v_mfma_f32_16x16x32_bf16 v[84:87], v[104:107], v[20:23], v[84:87]
    ds_read_b128 v[128:131], v8 offset:52224
    v_mfma_f32_16x16x32_bf16 v[68:71], v[108:111], v[16:19], v[68:71]
    ds_read_b128 v[132:135], v8 offset:53248
    v_mfma_f32_16x16x32_bf16 v[88:91], v[108:111], v[20:23], v[88:91]
    ds_read_b128 v[136:139], v8 offset:54272
    s_waitcnt lgkmcnt(4)
    v_mfma_f32_16x16x32_bf16 v[72:75], v[112:115], v[16:19], v[72:75]
    ds_read_b128 v[140:143], v8 offset:55296
    v_mfma_f32_16x16x32_bf16 v[92:95], v[112:115], v[20:23], v[92:95]
    v_mfma_f32_16x16x32_bf16 v[76:79], v[116:119], v[16:19], v[76:79]
    buffer_load_dword v15, v14, s[16:19], s74 offen sc1
    v_mfma_f32_16x16x32_bf16 v[96:99], v[116:119], v[20:23], v[96:99]
    v_mfma_f32_16x16x32_bf16 v[80:83], v[120:123], v[16:19], v[80:83]
    v_mfma_f32_16x16x32_bf16 v[100:103], v[120:123], v[20:23], v[100:103]
    s_waitcnt lgkmcnt(0)
    s_barrier
    s_waitcnt vmcnt(11)
    v_mfma_f32_16x16x32_bf16 v[64:67], v[124:127], v[24:27], v[64:67]
    ds_read_b128 v[104:107], v9 offset:0
    v_mfma_f32_16x16x32_bf16 v[84:87], v[124:127], v[28:31], v[84:87]
    ds_read_b128 v[108:111], v9 offset:1024
    v_mfma_f32_16x16x32_bf16 v[68:71], v[128:131], v[24:27], v[68:71]
    ds_read_b128 v[112:115], v9 offset:2048
    v_mfma_f32_16x16x32_bf16 v[88:91], v[128:131], v[28:31], v[88:91]
    ds_read_b128 v[116:119], v9 offset:3072
    v_mfma_f32_16x16x32_bf16 v[72:75], v[132:135], v[24:27], v[72:75]
    ds_read_b128 v[120:123], v9 offset:4096
    v_mfma_f32_16x16x32_bf16 v[92:95], v[132:135], v[28:31], v[92:95]
    v_mfma_f32_16x16x32_bf16 v[76:79], v[136:139], v[24:27], v[76:79]
    v_mfma_f32_16x16x32_bf16 v[96:99], v[136:139], v[28:31], v[96:99]
    v_mfma_f32_16x16x32_bf16 v[80:83], v[140:143], v[24:27], v[80:83]
    v_mfma_f32_16x16x32_bf16 v[100:103], v[140:143], v[28:31], v[100:103]
    s_waitcnt lgkmcnt(3)
    s_waitcnt vmcnt(9)
    v_mfma_f32_16x16x32_bf16 v[64:67], v[104:107], v[32:35], v[64:67]
    ds_read_b128 v[124:127], v9 offset:10240
    v_mfma_f32_16x16x32_bf16 v[84:87], v[104:107], v[36:39], v[84:87]
    ds_read_b128 v[128:131], v9 offset:11264
    v_mfma_f32_16x16x32_bf16 v[68:71], v[108:111], v[32:35], v[68:71]
    ds_read_b128 v[132:135], v9 offset:12288
    v_mfma_f32_16x16x32_bf16 v[88:91], v[108:111], v[36:39], v[88:91]
    ds_read_b128 v[136:139], v9 offset:13312
    s_waitcnt lgkmcnt(4)
    v_mfma_f32_16x16x32_bf16 v[72:75], v[112:115], v[32:35], v[72:75]
    ds_read_b128 v[140:143], v9 offset:14336
    v_mfma_f32_16x16x32_bf16 v[92:95], v[112:115], v[36:39], v[92:95]
    v_mfma_f32_16x16x32_bf16 v[76:79], v[116:119], v[32:35], v[76:79]
    v_mfma_f32_16x16x32_bf16 v[96:99], v[116:119], v[36:39], v[96:99]
    v_mfma_f32_16x16x32_bf16 v[80:83], v[120:123], v[32:35], v[80:83]
    v_mfma_f32_16x16x32_bf16 v[100:103], v[120:123], v[36:39], v[100:103]
    s_waitcnt lgkmcnt(3)
    s_waitcnt vmcnt(7)
    v_mfma_f32_16x16x32_bf16 v[64:67], v[124:127], v[40:43], v[64:67]
    ds_read_b128 v[104:107], v9 offset:20480
    v_mfma_f32_16x16x32_bf16 v[84:87], v[124:127], v[44:47], v[84:87]
    ds_read_b128 v[108:111], v9 offset:21504
    v_mfma_f32_16x16x32_bf16 v[68:71], v[128:131], v[40:43], v[68:71]
    ds_read_b128 v[112:115], v9 offset:22528
    v_mfma_f32_16x16x32_bf16 v[88:91], v[128:131], v[44:47], v[88:91]
    ds_read_b128 v[116:119], v9 offset:23552
    s_waitcnt lgkmcnt(4)
    v_mfma_f32_16x16x32_bf16 v[72:75], v[132:135], v[40:43], v[72:75]
    ds_read_b128 v[120:123], v9 offset:24576
    v_mfma_f32_16x16x32_bf16 v[92:95], v[132:135], v[44:47], v[92:95]
    v_mfma_f32_16x16x32_bf16 v[76:79], v[136:139], v[40:43], v[76:79]
    v_mfma_f32_16x16x32_bf16 v[96:99], v[136:139], v[44:47], v[96:99]
    v_mfma_f32_16x16x32_bf16 v[80:83], v[140:143], v[40:43], v[80:83]
    v_mfma_f32_16x16x32_bf16 v[100:103], v[140:143], v[44:47], v[100:103]
    s_waitcnt lgkmcnt(3)
    s_waitcnt vmcnt(5)
    v_mfma_f32_16x16x32_bf16 v[64:67], v[104:107], v[48:51], v[64:67]
    ds_read_b128 v[124:127], v9 offset:30720
    v_mfma_f32_16x16x32_bf16 v[84:87], v[104:107], v[52:55], v[84:87]
    ds_read_b128 v[128:131], v9 offset:31744
    v_mfma_f32_16x16x32_bf16 v[68:71], v[108:111], v[48:51], v[68:71]
    ds_read_b128 v[132:135], v9 offset:32768
    v_mfma_f32_16x16x32_bf16 v[88:91], v[108:111], v[52:55], v[88:91]
    ds_read_b128 v[136:139], v9 offset:33792
    s_waitcnt lgkmcnt(4)
    v_mfma_f32_16x16x32_bf16 v[72:75], v[112:115], v[48:51], v[72:75]
    ds_read_b128 v[140:143], v9 offset:34816
    v_mfma_f32_16x16x32_bf16 v[92:95], v[112:115], v[52:55], v[92:95]
    v_mfma_f32_16x16x32_bf16 v[76:79], v[116:119], v[48:51], v[76:79]
    v_mfma_f32_16x16x32_bf16 v[96:99], v[116:119], v[52:55], v[96:99]
    v_mfma_f32_16x16x32_bf16 v[80:83], v[120:123], v[48:51], v[80:83]
    v_mfma_f32_16x16x32_bf16 v[100:103], v[120:123], v[52:55], v[100:103]
    s_waitcnt lgkmcnt(3)
    s_waitcnt vmcnt(3)
    v_mfma_f32_16x16x32_bf16 v[84:87], v[124:127], v[60:63], v[84:87]
    ds_read_b128 v[104:107], v9 offset:40960
    v_mfma_f32_16x16x32_bf16 v[88:91], v[128:131], v[60:63], v[88:91]
    ds_read_b128 v[108:111], v9 offset:41984
    s_waitcnt lgkmcnt(2)
    v_mfma_f32_16x16x32_bf16 v[92:95], v[132:135], v[60:63], v[92:95]
    ds_read_b128 v[112:115], v9 offset:43008
    v_mfma_f32_16x16x32_bf16 v[96:99], v[136:139], v[60:63], v[96:99]
    ds_read_b128 v[116:119], v9 offset:44032
    v_mfma_f32_16x16x32_bf16 v[100:103], v[140:143], v[60:63], v[100:103]
    ds_read_b128 v[120:123], v9 offset:45056
    s_waitcnt lgkmcnt(3)
    s_waitcnt vmcnt(1)
    v_mfma_f32_16x16x32_bf16 v[84:87], v[104:107], v[196:199], v[84:87]
    v_mfma_f32_16x16x32_bf16 v[88:91], v[108:111], v[196:199], v[88:91]
    s_waitcnt lgkmcnt(0)
    v_mfma_f32_16x16x32_bf16 v[92:95], v[112:115], v[196:199], v[92:95]
    v_mfma_f32_16x16x32_bf16 v[96:99], v[116:119], v[196:199], v[96:99]
    v_mfma_f32_16x16x32_bf16 v[100:103], v[120:123], v[196:199], v[100:103]
    v_mfma_f32_16x16x32_bf16 v[64:67], v[124:127], v[56:59], v[64:67]
    v_mfma_f32_16x16x32_bf16 v[68:71], v[128:131], v[56:59], v[68:71]
    s_nop 0
    ds_write_b128 v12, v[84:87] offset:0
    v_mfma_f32_16x16x32_bf16 v[72:75], v[132:135], v[56:59], v[72:75]
    ds_write_b128 v12, v[88:91] offset:1024
    v_mfma_f32_16x16x32_bf16 v[76:79], v[136:139], v[56:59], v[76:79]
    ds_write_b128 v12, v[92:95] offset:2048
    v_mfma_f32_16x16x32_bf16 v[80:83], v[140:143], v[56:59], v[80:83]
    ds_write_b128 v12, v[96:99] offset:3072
    v_mfma_f32_16x16x32_bf16 v[64:67], v[104:107], v[192:195], v[64:67]
    ds_write_b128 v12, v[100:103] offset:4096
    v_mfma_f32_16x16x32_bf16 v[68:71], v[108:111], v[192:195], v[68:71]
    v_mfma_f32_16x16x32_bf16 v[72:75], v[112:115], v[192:195], v[72:75]
    v_mfma_f32_16x16x32_bf16 v[76:79], v[116:119], v[192:195], v[76:79]
    v_mfma_f32_16x16x32_bf16 v[80:83], v[120:123], v[192:195], v[80:83]
    s_xor_b32 s81, s3, 2
    s_mul_i32 s81, s81, 5120
    s_add_u32 s81, s81, 143360
    v_add_u32 v12, s81, v1
    s_waitcnt vmcnt(0)
    v_cmp_eq_u32 vcc, 0, v15
    s_nop 0
    s_or_b32 s92, vcc_lo, vcc_hi
    s_cbranch_scc0 L_ok_9
    s_mov_b32 s90, 0
L_poll_10:
    buffer_load_dword v15, v14, s[16:19], s74 offen sc1
    s_waitcnt vmcnt(0)
    v_cmp_eq_u32 vcc, 0, v15
    s_nop 0
    s_or_b32 s92, vcc_lo, vcc_hi
    s_cbranch_scc0 L_pdone_11
    s_sleep 4
    s_add_u32 s90, s90, 1
    s_cmp_lt_u32 s90, 40000
    s_cbranch_scc1 L_poll_10
L_pdone_11:
L_ok_9:
    v_lshlrev_b32 v14, 16, v15
    v_and_b32 v15, 0xffff0000, v15
    s_waitcnt lgkmcnt(0)
    s_barrier
    ds_read_b128 v[104:107], v12 offset:0
    ds_read_b64_tr_b16 v[124:125], v3 offset:0
    ds_read_b128 v[108:111], v12 offset:1024
    ds_read_b64_tr_b16 v[126:127], v3 offset:2048
    ds_read_b128 v[112:115], v12 offset:2048
    ds_read_b64_tr_b16 v[128:129], v3 offset:4096
    ds_read_b128 v[116:119], v12 offset:3072
    ds_read_b64_tr_b16 v[130:131], v3 offset:6144
    ds_read_b128 v[120:123], v12 offset:4096
    ds_read_b64_tr_b16 v[132:133], v3 offset:8192
    s_waitcnt lgkmcnt(8)
    v_add_f32 v64, v64, v104
    v_add_f32 v65, v65, v105
    v_add_f32 v66, v66, v106
    v_add_f32 v67, v67, v107
    v_lshlrev_b32 v104, 16, v124
    v_and_b32 v105, 0xffff0000, v124
    v_lshlrev_b32 v106, 16, v125
    v_and_b32 v107, 0xffff0000, v125
    v_mul_f32 v64, v15, v64
    v_mul_f32 v65, v15, v65
    v_mul_f32 v66, v15, v66
    v_mul_f32 v67, v15, v67
    v_fmac_f32 v64, v14, v104
    v_fmac_f32 v65, v14, v105
    v_fmac_f32 v66, v14, v106
    v_fmac_f32 v67, v14, v107
    v_cvt_pk_bf16_f32 v16, v64, v65
    v_cvt_pk_bf16_f32 v17, v66, v67
    s_waitcnt lgkmcnt(6)
    v_add_f32 v68, v68, v108
    v_add_f32 v69, v69, v109
    v_add_f32 v70, v70, v110
    v_add_f32 v71, v71, v111
    v_lshlrev_b32 v108, 16, v126
    v_and_b32 v109, 0xffff0000, v126
    v_lshlrev_b32 v110, 16, v127
    v_and_b32 v111, 0xffff0000, v127
    v_mul_f32 v68, v15, v68
    v_mul_f32 v69, v15, v69
    v_mul_f32 v70, v15, v70
    v_mul_f32 v71, v15, v71
    v_fmac_f32 v68, v14, v108
    v_fmac_f32 v69, v14, v109
    v_fmac_f32 v70, v14, v110
    v_fmac_f32 v71, v14, v111
    v_cvt_pk_bf16_f32 v18, v68, v69
    v_cvt_pk_bf16_f32 v19, v70, v71
    s_nop 0
    v_permlane16_swap_b32 v16, v18
    v_permlane16_swap_b32 v17, v19
    buffer_store_dwordx4 v[16:19], v5, s[20:23], s75 offen offset:0
    s_waitcnt lgkmcnt(4)
    v_add_f32 v72, v72, v112
    v_add_f32 v73, v73, v113
    v_add_f32 v74, v74, v114
    v_add_f32 v75, v75, v115
    v_lshlrev_b32 v112, 16, v128
    v_and_b32 v113, 0xffff0000, v128
    v_lshlrev_b32 v114, 16, v129
    v_and_b32 v115, 0xffff0000, v129
    v_mul_f32 v72, v15, v72
    v_mul_f32 v73, v15, v73
    v_mul_f32 v74, v15, v74
    v_mul_f32 v75, v15, v75
    v_fmac_f32 v72, v14, v112
    v_fmac_f32 v73, v14, v113
    v_fmac_f32 v74, v14, v114
    v_fmac_f32 v75, v14, v115
    v_cvt_pk_bf16_f32 v20, v72, v73
    v_cvt_pk_bf16_f32 v21, v74, v75
    s_waitcnt lgkmcnt(2)
    v_add_f32 v76, v76, v116
    v_add_f32 v77, v77, v117
    v_add_f32 v78, v78, v118
    v_add_f32 v79, v79, v119
    v_lshlrev_b32 v116, 16, v130
    v_and_b32 v117, 0xffff0000, v130
    v_lshlrev_b32 v118, 16, v131
    v_and_b32 v119, 0xffff0000, v131
    v_mul_f32 v76, v15, v76
    v_mul_f32 v77, v15, v77
    v_mul_f32 v78, v15, v78
    v_mul_f32 v79, v15, v79
    v_fmac_f32 v76, v14, v116
    v_fmac_f32 v77, v14, v117
    v_fmac_f32 v78, v14, v118
    v_fmac_f32 v79, v14, v119
    v_cvt_pk_bf16_f32 v22, v76, v77
    v_cvt_pk_bf16_f32 v23, v78, v79
    s_nop 0
    v_permlane16_swap_b32 v20, v22
    v_permlane16_swap_b32 v21, v23
    buffer_store_dwordx4 v[20:23], v5, s[20:23], s75 offen offset:64
    s_waitcnt lgkmcnt(0)
    v_add_f32 v80, v80, v120
    v_add_f32 v81, v81, v121
    v_add_f32 v82, v82, v122
    v_add_f32 v83, v83, v123
    v_lshlrev_b32 v120, 16, v132
    v_and_b32 v121, 0xffff0000, v132
    v_lshlrev_b32 v122, 16, v133
    v_and_b32 v123, 0xffff0000, v133
    v_mul_f32 v80, v15, v80
    v_mul_f32 v81, v15, v81
    v_mul_f32 v82, v15, v82
    v_mul_f32 v83, v15, v83
    v_fmac_f32 v80, v14, v120
    v_fmac_f32 v81, v14, v121
    v_fmac_f32 v82, v14, v122
    v_fmac_f32 v83, v14, v123
    v_cvt_pk_bf16_f32 v24, v80, v81
    v_cvt_pk_bf16_f32 v25, v82, v83
    buffer_store_dwordx2 v[24:25], v4, s[20:23], s75 offen offset:128
    s_branch L_fin
L_helper:
    s_setprio 3
    s_cmp_eq_u32 s54, 1
    s_cbranch_scc1 L_help_large
    v_lshrrev_b32 v3, 3, v2
    v_and_b32 v4, 7, v2
    v_lshrrev_b32 v5, 4, v2
    v_xor_b32 v5, v4, v5
    v_lshlrev_b32 v5, 4, v5
    s_mul_i32 s80, s56, 48
    s_add_u32 s80, s80, s53
    s_mul_i32 s80, s80, 1280
    v_mul_u32_u24 v6, 1280, v3
    v_add3_u32 v8, v6, v5, s80
    v_xor_b32 v9, 64, v8
    v_add_u32 v10, 18432, v8
    v_add_u32 v11, 27648, v9
    v_add_u32 v12, 40960, v8
    v_add_u32 v13, 50176, v9
    v_add_u32 v9, 9216, v9
    v_bfe_u32 v5, v2, 4, 1
    v_lshlrev_b32 v5, 2, v5
    v_xor_b32 v5, v4, v5
    v_lshlrev_b32 v5, 4, v5
    s_mul_i32 s80, s56, 55296
    s_lshl_b32 s81, s52, 7
    s_add_u32 s80, s80, s81
    v_mul_u32_u24 v6, 3456, v3
    v_add3_u32 v16, v6, v5, s80
    v_add_u32 v17, 26624, v16
    s_mul_i32 s73, s56, 6144
    s_lshl_b32 s74, s56, 11
    s_add_u32 s74, s74, 24576
    s_lshl_b32 s70, s59, 7
    s_add_u32 m0, s73, 0
    s_mul_i32 s71, s70, 1728
    buffer_load_dwordx4 v8, s[4:7], s70 offen offset:0 lds
    buffer_load_dwordx4 v9, s[4:7], s70 offen offset:1024 lds
    buffer_load_dwordx4 v10, s[4:7], s70 offen offset:2048 lds
    buffer_load_dwordx4 v11, s[4:7], s70 offen offset:3072 lds
    s_add_u32 m0, s73, 4096
    s_nop 0
    buffer_load_dwordx4 v12, s[4:7], s70 offen offset:0 lds
    buffer_load_dwordx4 v13, s[4:7], s70 offen offset:1024 lds
    s_add_u32 m0, s74, 0
    s_nop 0
    buffer_load_dwordx4 v16, s[8:11], s71 offen lds
    s_add_u32 s70, s70, 128
    s_cmp_eq_u32 s70, 1280
    s_cselect_b32 s70, 0, s70
    buffer_load_dwordx4 v17, s[8:11], s71 offen offset:1024 lds
    s_add_u32 m0, s74, 8192
    s_nop 0
    buffer_load_dwordx4 v16, s[12:15], s71 offen lds
    buffer_load_dwordx4 v17, s[12:15], s71 offen offset:1024 lds
    s_setprio 1
    v_min_u32 v254, 0, v2
    v_lshlrev_b32 v254, 2, v254
    s_and_b32 s84, s61, 1
    s_mul_i32 s84, s84, 96
    v_lshrrev_b32 v228, 4, v2
    v_bfe_u32 v229, v2, 2, 2
    v_lshl_add_u32 v230, v228, 3, v229
    v_add_u32 v230, s84, v230
    v_lshlrev_b32 v230, 7, v230
    v_lshrrev_b32 v229, 1, v229
    v_and_b32 v231, 1, v228
    v_lshl_or_b32 v229, v231, 2, v229
    v_bfe_u32 v231, v2, 1, 1
    s_lshl_b32 s85, s56, 1
    v_or_b32 v231, s85, v231
    v_xor_b32 v229, v229, v231
    v_lshlrev_b32 v229, 4, v229
    v_and_b32 v231, 1, v2
    v_lshlrev_b32 v231, 3, v231
    v_add3_u32 v249, v230, v229, v231
    v_xor_b32 v229, 32, v249
    v_add_u32 v250, 512, v229
    v_and_b32 v229, 15, v2
    v_lshlrev_b32 v229, 6, v229
    v_lshl_add_u32 v251, v228, 4, v229
    s_add_u32 s85, s59, s60
    s_cmp_ge_u32 s85, 10
    s_cselect_b32 s86, 10, 0
    s_sub_u32 s85, s85, s86
    s_lshl_b32 s85, s85, 2
    s_add_u32 s85, s85, s56
    s_lshl_b32 s86, s85, 16
    s_add_u32 s84, s84, s53
    s_lshl_b32 s84, s84, 5
    s_add_u32 s86, s86, s84
    s_add_u32 s75, s86, 65536
    s_lshr_b32 s82, s3, 2
    s_mul_i32 s82, s82, 40960
    s_mul_i32 s81, s56, 8704
    s_sub_u32 s81, s81, s82
    s_add_u32 s89, s81, 122880
    s_mov_b32 m0, s89
    v_and_b32 v4, 31, v2
    v_mul_u32_u24 v4, 272, v4
    v_lshrrev_b32 v5, 5, v2
    v_lshlrev_b32 v5, 4, v5
    v_add3_u32 v58, v4, v5, s89
    s_mov_b32 s83, 0x3fb8aa3b
    s_mov_b32 s84, 0x3fb8aa3b
    s_mov_b32 s85, 0x3e22f983
    s_mov_b32 s86, 0x4138aa3b
    s_mov_b32 s87, 0x3fa2f983
    s_mov_b32 s90, 0x43b8aa3b
    s_mov_b32 s91, 0x4222f983
    s_waitcnt vmcnt(10)
    v_lshlrev_b32 v26, 16, v26
    v_lshlrev_b32 v20, 16, v20
    v_mul_f32 v28, s83, v26
    v_lshlrev_b32 v21, 16, v21
    v_fma_f32 v29, v26, s83, -v28
    v_exp_f32 v30, v28
    v_fmac_f32 v29, 0x32a57060, v26
    v_lshlrev_b32 v22, 16, v22
    v_mul_f32 v29, 0x3f317218, v29
    v_lshlrev_b32 v23, 16, v23
    v_fmac_f32 v30, v30, v29
    v_lshlrev_b32 v24, 16, v24
    v_cvt_pk_bf16_f32 v30, v30, v30
    v_lshlrev_b32 v25, 16, v25
    v_lshlrev_b32 v32, 16, v30
    v_mov_b32 v34, 0x3f80
    v_pk_mul_f32 v[20:21], v[20:21], v[32:33] op_sel_hi:[1,0]
    v_pk_mul_f32 v[22:23], v[22:23], v[32:33] op_sel_hi:[1,0]
    v_pk_mul_f32 v[36:37], v[20:21], s[86:87]
    v_pk_mul_f32 v[38:39], v[20:21], s[90:91]
    v_fract_f32 v35, v37
    v_exp_f32 v40, v36
    v_cos_f32 v42, v35
    v_fract_f32 v44, v39
    v_exp_f32 v46, v38
    v_sin_f32 v43, v35
    v_cos_f32 v48, v44
    v_pk_mul_f32 v[50:51], v[24:25], v[22:23] op_sel:[0,0] op_sel_hi:[0,1]
    v_pk_mul_f32 v[52:53], v[42:43], v[40:41] op_sel_hi:[1,0]
    v_sin_f32 v49, v44
    v_pk_fma_f32 v[50:51], v[24:25], v[22:23], v[50:51] op_sel:[1,1,0] op_sel_hi:[1,0,1] neg_lo:[0,1,0]
    v_pk_mul_f32 v[54:55], v[20:21], s[84:85]
    v_cvt_pk_bf16_f32 v35, v50, v51
    v_pk_mul_f32 v[56:57], v[48:49], v[46:47] op_sel_hi:[1,0]
    ds_write_addtid_b32 v35 offset:0
    v_pk_mul_f32 v[96:97], v[50:51], v[56:57] op_sel:[0,0] op_sel_hi:[0,1]
    v_fract_f32 v35, v55
    v_pk_fma_f32 v[96:97], v[50:51], v[56:57], v[96:97] op_sel:[1,1,0] op_sel_hi:[1,0,1] neg_lo:[0,1,0]
    v_cos_f32 v98, v35
    v_cvt_pk_bf16_f32 v100, v96, v97
    v_pk_mul_f32 v[102:103], v[96:97], v[56:57] op_sel:[0,0] op_sel_hi:[0,1]
    ds_write_addtid_b32 v100 offset:1088
    v_pk_fma_f32 v[102:103], v[96:97], v[56:57], v[102:103] op_sel:[1,1,0] op_sel_hi:[1,0,1] neg_lo:[0,1,0]
    v_exp_f32 v104, v54
    v_cvt_pk_bf16_f32 v101, v102, v103
    ds_write_addtid_b32 v100 offset:1360
    v_pk_mul_f32 v[106:107], v[102:103], v[56:57] op_sel:[0,0] op_sel_hi:[0,1]
    v_sin_f32 v99, v35
    v_pk_fma_f32 v[106:107], v[102:103], v[56:57], v[106:107] op_sel:[1,1,0] op_sel_hi:[1,0,1] neg_lo:[0,1,0]
    ds_write_addtid_b32 v101 offset:4352
    v_cvt_pk_bf16_f32 v35, v106, v107
    v_pk_mul_f32 v[108:109], v[106:107], v[56:57] op_sel:[0,0] op_sel_hi:[0,1]
    v_pk_mul_f32 v[110:111], v[98:99], v[104:105] op_sel_hi:[1,0]
    ds_write_addtid_b32 v35 offset:5440
    v_pk_fma_f32 v[108:109], v[106:107], v[56:57], v[108:109] op_sel:[1,1,0] op_sel_hi:[1,0,1] neg_lo:[0,1,0]
    v_pk_mul_f32 v[112:113], v[110:111], v[110:111] op_sel:[0,0] op_sel_hi:[0,1]
    v_cvt_pk_bf16_f32 v35, v108, v109
    v_pk_mul_f32 v[114:115], v[50:51], v[110:111] op_sel:[0,0] op_sel_hi:[0,1]
    ds_write_addtid_b32 v35 offset:5168
    v_pk_mul_f32 v[116:117], v[108:109], v[56:57] op_sel:[0,0] op_sel_hi:[0,1]
    v_pk_fma_f32 v[112:113], v[110:111], v[110:111], v[112:113] op_sel:[1,1,0] op_sel_hi:[1,0,1] neg_lo:[0,1,0]
    v_pk_fma_f32 v[114:115], v[50:51], v[110:111], v[114:115] op_sel:[1,1,0] op_sel_hi:[1,0,1] neg_lo:[0,1,0]
    v_pk_fma_f32 v[116:117], v[108:109], v[56:57], v[116:117] op_sel:[1,1,0] op_sel_hi:[1,0,1] neg_lo:[0,1,0]
    v_cvt_pk_bf16_f32 v35, v114, v115
    v_cvt_pk_bf16_f32 v118, v116, v117
    ds_write_addtid_b32 v35 offset:272
    v_pk_mul_f32 v[120:121], v[112:113], v[112:113] op_sel:[0,0] op_sel_hi:[0,1]
    v_pk_mul_f32 v[122:123], v[50:51], v[112:113] op_sel:[0,0] op_sel_hi:[0,1]
    v_pk_mul_f32 v[124:125], v[114:115], v[112:113] op_sel:[0,0] op_sel_hi:[0,1]
    ds_write_addtid_b32 v118 offset:6256
    v_pk_mul_f32 v[126:127], v[116:117], v[56:57] op_sel:[0,0] op_sel_hi:[0,1]
    v_pk_fma_f32 v[120:121], v[112:113], v[112:113], v[120:121] op_sel:[1,1,0] op_sel_hi:[1,0,1] neg_lo:[0,1,0]
    v_pk_fma_f32 v[122:123], v[50:51], v[112:113], v[122:123] op_sel:[1,1,0] op_sel_hi:[1,0,1] neg_lo:[0,1,0]
    v_pk_fma_f32 v[124:125], v[114:115], v[112:113], v[124:125] op_sel:[1,1,0] op_sel_hi:[1,0,1] neg_lo:[0,1,0]
    v_cvt_pk_bf16_f32 v35, v122, v123
    v_cvt_pk_bf16_f32 v28, v124, v125
    ds_write_addtid_b32 v35 offset:544
    v_pk_fma_f32 v[126:127], v[116:117], v[56:57], v[126:127] op_sel:[1,1,0] op_sel_hi:[1,0,1] neg_lo:[0,1,0]
    v_pk_mul_f32 v[30:31], v[122:123], v[112:113] op_sel:[0,0] op_sel_hi:[0,1]
    v_cvt_pk_bf16_f32 v29, v126, v127
    ds_write_addtid_b32 v28 offset:816
    v_pk_mul_f32 v[32:33], v[124:125], v[112:113] op_sel:[0,0] op_sel_hi:[0,1]
    v_pk_mul_f32 v[36:37], v[96:97], v[120:121] op_sel:[0,0] op_sel_hi:[0,1]
    v_pk_mul_f32 v[38:39], v[126:127], v[56:57] op_sel:[0,0] op_sel_hi:[0,1]
    ds_write_addtid_b32 v29 offset:6800
    v_pk_fma_f32 v[30:31], v[122:123], v[112:113], v[30:31] op_sel:[1,1,0] op_sel_hi:[1,0,1] neg_lo:[0,1,0]
    v_pk_fma_f32 v[32:33], v[124:125], v[112:113], v[32:33] op_sel:[1,1,0] op_sel_hi:[1,0,1] neg_lo:[0,1,0]
    v_cvt_pk_bf16_f32 v35, v30, v31
    v_cvt_pk_bf16_f32 v42, v32, v33
    ds_write_addtid_b32 v35 offset:2176
    v_pk_fma_f32 v[36:37], v[96:97], v[120:121], v[36:37] op_sel:[1,1,0] op_sel_hi:[1,0,1] neg_lo:[0,1,0]
    v_pk_fma_f32 v[38:39], v[126:127], v[56:57], v[38:39] op_sel:[1,1,0] op_sel_hi:[1,0,1] neg_lo:[0,1,0]
    v_cvt_pk_bf16_f32 v43, v36, v37
    ds_write_addtid_b32 v42 offset:2448
    v_cvt_pk_bf16_f32 v35, v38, v39
    v_pk_mul_f32 v[40:41], v[30:31], v[112:113] op_sel:[0,0] op_sel_hi:[0,1]
    v_pk_mul_f32 v[44:45], v[32:33], v[112:113] op_sel:[0,0] op_sel_hi:[0,1]
    ds_write_addtid_b32 v43 offset:1904
    v_pk_mul_f32 v[48:49], v[96:97], v[112:113] op_sel:[0,0] op_sel_hi:[0,1]
    v_pk_mul_f32 v[46:47], v[36:37], v[112:113] op_sel:[0,0] op_sel_hi:[0,1]
    v_pk_mul_f32 v[54:55], v[96:97], v[52:53] op_sel:[0,0] op_sel_hi:[0,1]
    ds_write_addtid_b32 v43 offset:3264
    v_pk_mul_f32 v[100:101], v[102:103], v[120:121] op_sel:[0,0] op_sel_hi:[0,1]
    v_pk_mul_f32 v[98:99], v[102:103], v[52:53] op_sel:[0,0] op_sel_hi:[0,1]
    v_pk_mul_f32 v[104:105], v[106:107], v[120:121] op_sel:[0,0] op_sel_hi:[0,1]
    ds_write_addtid_b32 v43 offset:3536
    v_pk_mul_f32 v[110:111], v[106:107], v[52:53] op_sel:[0,0] op_sel_hi:[0,1]
    v_pk_mul_f32 v[118:119], v[108:109], v[52:53] op_sel:[0,0] op_sel_hi:[0,1]
    v_pk_mul_f32 v[50:51], v[116:117], v[52:53] op_sel:[0,0] op_sel_hi:[0,1]
    ds_write_addtid_b32 v35 offset:7888
    v_pk_mul_f32 v[114:115], v[126:127], v[52:53] op_sel:[0,0] op_sel_hi:[0,1]
    v_pk_mul_f32 v[28:29], v[38:39], v[52:53] op_sel:[0,0] op_sel_hi:[0,1]
    v_pk_fma_f32 v[40:41], v[30:31], v[112:113], v[40:41] op_sel:[1,1,0] op_sel_hi:[1,0,1] neg_lo:[0,1,0]
    v_pk_fma_f32 v[44:45], v[32:33], v[112:113], v[44:45] op_sel:[1,1,0] op_sel_hi:[1,0,1] neg_lo:[0,1,0]
    v_cvt_pk_bf16_f32 v35, v40, v41
    v_cvt_pk_bf16_f32 v122, v44, v45
    ds_write_addtid_b32 v35 offset:2720
    v_pk_fma_f32 v[48:49], v[96:97], v[112:113], v[48:49] op_sel:[1,1,0] op_sel_hi:[1,0,1] neg_lo:[0,1,0]
    v_pk_fma_f32 v[46:47], v[36:37], v[112:113], v[46:47] op_sel:[1,1,0] op_sel_hi:[1,0,1] neg_lo:[0,1,0]
    v_cvt_pk_bf16_f32 v123, v48, v49
    ds_write_addtid_b32 v122 offset:2992
    v_cvt_pk_bf16_f32 v35, v46, v47
    v_pk_fma_f32 v[54:55], v[96:97], v[52:53], v[54:55] op_sel:[1,1,0] op_sel_hi:[1,0,1] neg_lo:[0,1,0]
    v_pk_fma_f32 v[100:101], v[102:103], v[120:121], v[100:101] op_sel:[1,1,0] op_sel_hi:[1,0,1] neg_lo:[0,1,0]
    ds_write_addtid_b32 v123 offset:1632
    v_cvt_pk_bf16_f32 v124, v54, v55
    v_cvt_pk_bf16_f32 v125, v100, v101
    v_pk_fma_f32 v[98:99], v[102:103], v[52:53], v[98:99] op_sel:[1,1,0] op_sel_hi:[1,0,1] neg_lo:[0,1,0]
    ds_write_addtid_b32 v35 offset:3808
    v_cvt_pk_bf16_f32 v35, v98, v99
    v_pk_fma_f32 v[104:105], v[106:107], v[120:121], v[104:105] op_sel:[1,1,0] op_sel_hi:[1,0,1] neg_lo:[0,1,0]
    v_pk_fma_f32 v[110:111], v[106:107], v[52:53], v[110:111] op_sel:[1,1,0] op_sel_hi:[1,0,1] neg_lo:[0,1,0]
    ds_write_addtid_b32 v124 offset:4080
    v_cvt_pk_bf16_f32 v124, v104, v105
    v_cvt_pk_bf16_f32 v56, v110, v111
    v_pk_fma_f32 v[118:119], v[108:109], v[52:53], v[118:119] op_sel:[1,1,0] op_sel_hi:[1,0,1] neg_lo:[0,1,0]
    ds_write_addtid_b32 v125 offset:4624
    v_cvt_pk_bf16_f32 v57, v118, v119
    v_pk_fma_f32 v[50:51], v[116:117], v[52:53], v[50:51] op_sel:[1,1,0] op_sel_hi:[1,0,1] neg_lo:[0,1,0]
    v_pk_fma_f32 v[114:115], v[126:127], v[52:53], v[114:115] op_sel:[1,1,0] op_sel_hi:[1,0,1] neg_lo:[0,1,0]
    ds_write_addtid_b32 v35 offset:4896
    v_cvt_pk_bf16_f32 v125, v50, v51
    v_cvt_pk_bf16_f32 v35, v114, v115
    v_pk_fma_f32 v[28:29], v[38:39], v[52:53], v[28:29] op_sel:[1,1,0] op_sel_hi:[1,0,1] neg_lo:[0,1,0]
    ds_write_addtid_b32 v124 offset:5712
    v_cvt_pk_bf16_f32 v124, v28, v29
    v_pk_mul_f32 v[42:43], v[52:53], 1.0 op_sel_hi:[1,0] neg_hi:[1,0]
    ds_write_addtid_b32 v56 offset:5984
    v_cvt_pk_bf16_f32 v56, v42, v43
    v_pk_mul_f32 v[30:31], v[42:43], v[42:43] op_sel:[0,0] op_sel_hi:[0,1]
    ds_write_addtid_b32 v57 offset:6528
    v_pk_fma_f32 v[30:31], v[42:43], v[42:43], v[30:31] op_sel:[1,1,0] op_sel_hi:[1,0,1] neg_lo:[0,1,0]
    ds_write_addtid_b32 v125 offset:7616
    v_cvt_pk_bf16_f32 v57, v30, v31
    v_pk_mul_f32 v[32:33], v[42:43], v[30:31] op_sel:[0,0] op_sel_hi:[0,1]
    v_pk_mul_f32 v[40:41], v[30:31], v[30:31] op_sel:[0,0] op_sel_hi:[0,1]
    ds_write_addtid_b32 v35 offset:7072
    v_pk_fma_f32 v[32:33], v[42:43], v[30:31], v[32:33] op_sel:[1,1,0] op_sel_hi:[1,0,1] neg_lo:[0,1,0]
    v_pk_fma_f32 v[40:41], v[30:31], v[30:31], v[40:41] op_sel:[1,1,0] op_sel_hi:[1,0,1] neg_lo:[0,1,0]
    v_cvt_pk_bf16_f32 v125, v32, v33
    ds_write_addtid_b32 v124 offset:8160
    v_cvt_pk_bf16_f32 v35, v40, v41
    v_pk_mul_f32 v[44:45], v[32:33], v[30:31] op_sel:[0,0] op_sel_hi:[0,1]
    v_pk_mul_f32 v[36:37], v[40:41], v[30:31] op_sel:[0,0] op_sel_hi:[0,1]
    ds_read_b128 v[64:67], v58 offset:0
    v_pk_fma_f32 v[44:45], v[32:33], v[30:31], v[44:45] op_sel:[1,1,0] op_sel_hi:[1,0,1] neg_lo:[0,1,0]
    v_pk_fma_f32 v[36:37], v[40:41], v[30:31], v[36:37] op_sel:[1,1,0] op_sel_hi:[1,0,1] neg_lo:[0,1,0]
    v_cvt_pk_bf16_f32 v124, v44, v45
    s_add_u32 m0, s73, 40960
    s_mul_i32 s71, s70, 1728
    buffer_load_dwordx4 v8, s[4:7], s70 offen offset:0 lds
    buffer_load_dwordx4 v9, s[4:7], s70 offen offset:1024 lds
    buffer_load_dwordx4 v10, s[4:7], s70 offen offset:2048 lds
    buffer_load_dwordx4 v11, s[4:7], s70 offen offset:3072 lds
    s_mov_b32 m0, s89
    ds_read_b128 v[68:71], v58 offset:32
    v_cvt_pk_bf16_f32 v112, v36, v37
    v_pk_mul_f32 v[48:49], v[44:45], v[30:31] op_sel:[0,0] op_sel_hi:[0,1]
    v_pk_mul_f32 v[46:47], v[36:37], v[30:31] op_sel:[0,0] op_sel_hi:[0,1]
    ds_read_b128 v[72:75], v58 offset:64
    v_pk_fma_f32 v[48:49], v[44:45], v[30:31], v[48:49] op_sel:[1,1,0] op_sel_hi:[1,0,1] neg_lo:[0,1,0]
    v_pk_fma_f32 v[46:47], v[36:37], v[30:31], v[46:47] op_sel:[1,1,0] op_sel_hi:[1,0,1] neg_lo:[0,1,0]
    v_cvt_pk_bf16_f32 v113, v48, v49
    ds_read_b128 v[76:79], v58 offset:96
    v_cvt_pk_bf16_f32 v96, v46, v47
    v_pk_mul_f32 v[122:123], v[48:49], v[30:31] op_sel:[0,0] op_sel_hi:[0,1]
    v_pk_mul_f32 v[54:55], v[46:47], v[30:31] op_sel:[0,0] op_sel_hi:[0,1]
    ds_read_b128 v[80:83], v58 offset:128
    v_pk_fma_f32 v[122:123], v[48:49], v[30:31], v[122:123] op_sel:[1,1,0] op_sel_hi:[1,0,1] neg_lo:[0,1,0]
    v_pk_fma_f32 v[54:55], v[46:47], v[30:31], v[54:55] op_sel:[1,1,0] op_sel_hi:[1,0,1] neg_lo:[0,1,0]
    v_cvt_pk_bf16_f32 v97, v122, v123
    ds_read_b128 v[84:87], v58 offset:160
    v_cvt_pk_bf16_f32 v100, v54, v55
    v_pk_mul_f32 v[102:103], v[122:123], v[30:31] op_sel:[0,0] op_sel_hi:[0,1]
    v_pk_mul_f32 v[98:99], v[54:55], v[30:31] op_sel:[0,0] op_sel_hi:[0,1]
    ds_read_b128 v[88:91], v58 offset:192
    v_pk_fma_f32 v[102:103], v[122:123], v[30:31], v[102:103] op_sel:[1,1,0] op_sel_hi:[1,0,1] neg_lo:[0,1,0]
    v_pk_fma_f32 v[98:99], v[54:55], v[30:31], v[98:99] op_sel:[1,1,0] op_sel_hi:[1,0,1] neg_lo:[0,1,0]
    v_cvt_pk_bf16_f32 v101, v102, v103
    ds_read_b128 v[92:95], v58 offset:224
    v_cvt_pk_bf16_f32 v120, v98, v99
    v_pk_mul_f32 v[106:107], v[102:103], v[30:31] op_sel:[0,0] op_sel_hi:[0,1]
    v_pk_mul_f32 v[104:105], v[98:99], v[30:31] op_sel:[0,0] op_sel_hi:[0,1]
    ds_write_addtid_b32 v34
    v_pk_fma_f32 v[106:107], v[102:103], v[30:31], v[106:107] op_sel:[1,1,0] op_sel_hi:[1,0,1] neg_lo:[0,1,0]
    s_add_u32 m0, s73, 45056
    s_nop 0
    buffer_load_dwordx4 v12, s[4:7], s70 offen offset:0 lds
    buffer_load_dwordx4 v13, s[4:7], s70 offen offset:1024 lds
    s_mov_b32 m0, s89
    v_pk_fma_f32 v[104:105], v[98:99], v[30:31], v[104:105] op_sel:[1,1,0] op_sel_hi:[1,0,1] neg_lo:[0,1,0]
    v_cvt_pk_bf16_f32 v121, v106, v107
    ds_write_addtid_b32 v56 offset:272
    v_cvt_pk_bf16_f32 v34, v104, v105
    v_pk_mul_f32 v[110:111], v[106:107], v[30:31] op_sel:[0,0] op_sel_hi:[0,1]
    v_pk_mul_f32 v[108:109], v[104:105], v[30:31] op_sel:[0,0] op_sel_hi:[0,1]
    ds_write_addtid_b32 v57 offset:544
    v_pk_fma_f32 v[110:111], v[106:107], v[30:31], v[110:111] op_sel:[1,1,0] op_sel_hi:[1,0,1] neg_lo:[0,1,0]
    v_pk_fma_f32 v[108:109], v[104:105], v[30:31], v[108:109] op_sel:[1,1,0] op_sel_hi:[1,0,1] neg_lo:[0,1,0]
    v_cvt_pk_bf16_f32 v118, v110, v111
    ds_write_addtid_b32 v125 offset:816
    v_cvt_pk_bf16_f32 v119, v108, v109
    v_pk_mul_f32 v[116:117], v[110:111], v[30:31] op_sel:[0,0] op_sel_hi:[0,1]
    v_pk_mul_f32 v[126:127], v[108:109], v[30:31] op_sel:[0,0] op_sel_hi:[0,1]
    ds_write_addtid_b32 v35 offset:1088
    v_pk_fma_f32 v[116:117], v[110:111], v[30:31], v[116:117] op_sel:[1,1,0] op_sel_hi:[1,0,1] neg_lo:[0,1,0]
    v_pk_fma_f32 v[126:127], v[108:109], v[30:31], v[126:127] op_sel:[1,1,0] op_sel_hi:[1,0,1] neg_lo:[0,1,0]
    v_cvt_pk_bf16_f32 v125, v116, v117
    ds_write_addtid_b32 v124 offset:1360
    v_cvt_pk_bf16_f32 v35, v126, v127
    v_pk_mul_f32 v[50:51], v[116:117], v[30:31] op_sel:[0,0] op_sel_hi:[0,1]
    v_pk_mul_f32 v[114:115], v[126:127], v[30:31] op_sel:[0,0] op_sel_hi:[0,1]
    ds_write_addtid_b32 v112 offset:1632
    v_pk_fma_f32 v[50:51], v[116:117], v[30:31], v[50:51] op_sel:[1,1,0] op_sel_hi:[1,0,1] neg_lo:[0,1,0]
    v_pk_fma_f32 v[114:115], v[126:127], v[30:31], v[114:115] op_sel:[1,1,0] op_sel_hi:[1,0,1] neg_lo:[0,1,0]
    v_cvt_pk_bf16_f32 v124, v50, v51
    ds_write_addtid_b32 v113 offset:1904
    v_cvt_pk_bf16_f32 v38, v114, v115
    v_pk_mul_f32 v[28:29], v[50:51], v[30:31] op_sel:[0,0] op_sel_hi:[0,1]
    v_pk_mul_f32 v[52:53], v[114:115], v[30:31] op_sel:[0,0] op_sel_hi:[0,1]
    ds_write_addtid_b32 v96 offset:2176
    s_add_u32 m0, s74, 40960
    s_nop 0
    buffer_load_dwordx4 v16, s[8:11], s71 offen lds
    s_add_u32 s70, s70, 128
    s_cmp_eq_u32 s70, 1280
    s_cselect_b32 s70, 0, s70
    buffer_load_dwordx4 v17, s[8:11], s71 offen offset:1024 lds
    s_mov_b32 m0, s89
    v_pk_fma_f32 v[28:29], v[50:51], v[30:31], v[28:29] op_sel:[1,1,0] op_sel_hi:[1,0,1] neg_lo:[0,1,0]
    v_pk_fma_f32 v[52:53], v[114:115], v[30:31], v[52:53] op_sel:[1,1,0] op_sel_hi:[1,0,1] neg_lo:[0,1,0]
    v_cvt_pk_bf16_f32 v39, v28, v29
    ds_write_addtid_b32 v97 offset:2448
    v_cvt_pk_bf16_f32 v42, v52, v53
    v_pk_mul_f32 v[32:33], v[28:29], v[30:31] op_sel:[0,0] op_sel_hi:[0,1]
    v_pk_mul_f32 v[40:41], v[52:53], v[30:31] op_sel:[0,0] op_sel_hi:[0,1]
    ds_write_addtid_b32 v100 offset:2720
    v_pk_fma_f32 v[32:33], v[28:29], v[30:31], v[32:33] op_sel:[1,1,0] op_sel_hi:[1,0,1] neg_lo:[0,1,0]
    v_pk_fma_f32 v[40:41], v[52:53], v[30:31], v[40:41] op_sel:[1,1,0] op_sel_hi:[1,0,1] neg_lo:[0,1,0]
    v_cvt_pk_bf16_f32 v43, v32, v33
    ds_write_addtid_b32 v101 offset:2992
    v_cvt_pk_bf16_f32 v44, v40, v41
    v_pk_mul_f32 v[36:37], v[32:33], v[30:31] op_sel:[0,0] op_sel_hi:[0,1]
    v_pk_mul_f32 v[48:49], v[40:41], v[30:31] op_sel:[0,0] op_sel_hi:[0,1]
    ds_write_addtid_b32 v120 offset:3264
    v_pk_fma_f32 v[36:37], v[32:33], v[30:31], v[36:37] op_sel:[1,1,0] op_sel_hi:[1,0,1] neg_lo:[0,1,0]
    v_pk_fma_f32 v[48:49], v[40:41], v[30:31], v[48:49] op_sel:[1,1,0] op_sel_hi:[1,0,1] neg_lo:[0,1,0]
    v_cvt_pk_bf16_f32 v45, v36, v37
    ds_write_addtid_b32 v121 offset:3536
    v_cvt_pk_bf16_f32 v46, v48, v49
    v_pk_mul_f32 v[122:123], v[36:37], v[30:31] op_sel:[0,0] op_sel_hi:[0,1]
    v_pk_mul_f32 v[54:55], v[48:49], v[30:31] op_sel:[0,0] op_sel_hi:[0,1]
    ds_write_addtid_b32 v34 offset:3808
    v_pk_fma_f32 v[122:123], v[36:37], v[30:31], v[122:123] op_sel:[1,1,0] op_sel_hi:[1,0,1] neg_lo:[0,1,0]
    v_pk_fma_f32 v[54:55], v[48:49], v[30:31], v[54:55] op_sel:[1,1,0] op_sel_hi:[1,0,1] neg_lo:[0,1,0]
    v_cvt_pk_bf16_f32 v47, v122, v123
    ds_write_addtid_b32 v118 offset:4080
    v_cvt_pk_bf16_f32 v34, v54, v55
    v_pk_mul_f32 v[102:103], v[122:123], v[30:31] op_sel:[0,0] op_sel_hi:[0,1]
    v_pk_mul_f32 v[98:99], v[54:55], v[30:31] op_sel:[0,0] op_sel_hi:[0,1]
    s_add_u32 m0, s74, 49152
    s_nop 0
    buffer_load_dwordx4 v16, s[12:15], s71 offen lds
    buffer_load_dwordx4 v17, s[12:15], s71 offen offset:1024 lds
    s_mov_b32 m0, s89
    s_nop 0
    ds_write_addtid_b32 v119 offset:4352
    v_pk_fma_f32 v[102:103], v[122:123], v[30:31], v[102:103] op_sel:[1,1,0] op_sel_hi:[1,0,1] neg_lo:[0,1,0]
    v_pk_fma_f32 v[98:99], v[54:55], v[30:31], v[98:99] op_sel:[1,1,0] op_sel_hi:[1,0,1] neg_lo:[0,1,0]
    v_cvt_pk_bf16_f32 v56, v102, v103
    ds_write_addtid_b32 v125 offset:4624
    v_cvt_pk_bf16_f32 v57, v98, v99
    v_pk_mul_f32 v[106:107], v[102:103], v[30:31] op_sel:[0,0] op_sel_hi:[0,1]
    ds_write_addtid_b32 v35 offset:4896
    v_pk_fma_f32 v[106:107], v[102:103], v[30:31], v[106:107] op_sel:[1,1,0] op_sel_hi:[1,0,1] neg_lo:[0,1,0]
    ds_write_addtid_b32 v124 offset:5168
    v_cvt_pk_bf16_f32 v35, v106, v107
    ds_write_addtid_b32 v38 offset:5440
    ds_write_addtid_b32 v39 offset:5712
    ds_write_addtid_b32 v42 offset:5984
    ds_write_addtid_b32 v43 offset:6256
    ds_write_addtid_b32 v44 offset:6528
    ds_write_addtid_b32 v45 offset:6800
    ds_write_addtid_b32 v46 offset:7072
    ds_write_addtid_b32 v47 offset:7344
    ds_write_addtid_b32 v34 offset:7616
    ds_write_addtid_b32 v56 offset:7888
    ds_write_addtid_b32 v57 offset:8160
    ds_write_addtid_b32 v35 offset:8432
    ds_read_b128 v[96:99], v58 offset:0
    ds_read_b128 v[100:103], v58 offset:32
    ds_read_b128 v[104:107], v58 offset:64
    ds_read_b128 v[108:111], v58 offset:96
    ds_read_b128 v[112:115], v58 offset:128
    ds_read_b128 v[116:119], v58 offset:160
    ds_read_b128 v[120:123], v58 offset:192
    ds_read_b128 v[124:127], v58 offset:224
    s_waitcnt lgkmcnt(7)
    v_mfma_f32_32x32x16_bf16 v[48:63], v[64:67], v[96:99], 0
    s_waitcnt lgkmcnt(6)
    v_mfma_f32_32x32x16_bf16 v[48:63], v[68:71], v[100:103], v[48:63]
    s_waitcnt lgkmcnt(5)
    v_mfma_f32_32x32x16_bf16 v[48:63], v[72:75], v[104:107], v[48:63]
    s_waitcnt lgkmcnt(4)
    v_mfma_f32_32x32x16_bf16 v[48:63], v[76:79], v[108:111], v[48:63]
    s_waitcnt lgkmcnt(3)
    v_mfma_f32_32x32x16_bf16 v[48:63], v[80:83], v[112:115], v[48:63]
    s_waitcnt lgkmcnt(2)
    v_mfma_f32_32x32x16_bf16 v[48:63], v[84:87], v[116:119], v[48:63]
    s_waitcnt lgkmcnt(1)
    v_mfma_f32_32x32x16_bf16 v[48:63], v[88:91], v[120:123], v[48:63]
    s_waitcnt lgkmcnt(0)
    v_mfma_f32_32x32x16_bf16 v[48:63], v[92:95], v[124:127], v[48:63]
    s_waitcnt lgkmcnt(0)
    s_setprio 0
    s_waitcnt vmcnt(10)
    s_barrier
    buffer_load_dword v255, v254, s[28:31], 0 offen sc1
    s_add_u32 m0, s73, 81920
    s_mul_i32 s71, s70, 1728
    s_mul_i32 s80, s56, 8704
    s_add_u32 s80, s80, 122880
    buffer_load_dwordx4 v8, s[4:7], s70 offen offset:0 lds
    v_add_u32 v5, s80, v1
    ds_read_b128 v[96:99], v5 offset:0
    buffer_load_dwordx4 v9, s[4:7], s70 offen offset:1024 lds
    ds_read_b128 v[100:103], v5 offset:1024
    ds_read_b128 v[104:107], v5 offset:2048
    buffer_load_dwordx4 v10, s[4:7], s70 offen offset:2048 lds
    ds_read_b128 v[108:111], v5 offset:3072
    v_lshlrev_b32 v27, 16, v27
    buffer_load_dwordx4 v11, s[4:7], s70 offen offset:3072 lds
    v_cmp_eq_u32 vcc, 0, v2
    s_nop 1
    v_cndmask_b32 v27, 0, v27, vcc
    s_add_u32 m0, s73, 86016
    v_add_f32 v48, v48, v27
    s_waitcnt lgkmcnt(0)
    buffer_load_dwordx4 v12, s[4:7], s70 offen offset:0 lds
    v_add_f32 v96, v96, v48
    v_add_f32 v97, v97, v49
    v_add_f32 v98, v98, v50
    buffer_load_dwordx4 v13, s[4:7], s70 offen offset:1024 lds
    v_add_f32 v99, v99, v51
    v_add_f32 v100, v100, v52
    s_add_u32 m0, s74, 81920
    v_add_f32 v101, v101, v53
    v_add_f32 v102, v102, v54
    buffer_load_dwordx4 v16, s[8:11], s71 offen lds
    v_add_f32 v103, v103, v55
    v_add_f32 v104, v104, v56
    s_add_u32 s70, s70, 128
    s_cmp_eq_u32 s70, 1280
    s_cselect_b32 s70, 0, s70
    v_add_f32 v105, v105, v57
    v_add_f32 v106, v106, v58
    buffer_load_dwordx4 v17, s[8:11], s71 offen offset:1024 lds
    v_add_f32 v107, v107, v59
    v_add_f32 v108, v108, v60
    s_add_u32 m0, s74, 90112
    v_add_f32 v109, v109, v61
    v_add_f32 v110, v110, v62
    v_add_f32 v111, v111, v63
    buffer_load_dwordx4 v16, s[12:15], s71 offen lds
    buffer_load_dwordx4 v17, s[12:15], s71 offen offset:1024 lds
    s_waitcnt vmcnt(11)
    s_barrier
    s_cmp_eq_u32 s60, 1
    s_cbranch_scc0 L_c_12
    v_add_u32 v3, 40960, v249
    v_add_u32 v4, 40960, v250
    ds_read_b64_tr_b16 v[36:37], v3 offset:0
    ds_read_b64_tr_b16 v[38:39], v4 offset:0
    ds_read_b64_tr_b16 v[40:41], v3 offset:4096
    ds_read_b64_tr_b16 v[42:43], v4 offset:4096
    ds_read_b64_tr_b16 v[44:45], v3 offset:8192
    ds_read_b64_tr_b16 v[46:47], v4 offset:8192
L_c_12:
    s_add_u32 m0, s73, 0
    s_mul_i32 s71, s70, 1728
    v_cvt_pk_bf16_f32 v128, v103, v102
    buffer_load_dwordx4 v8, s[4:7], s70 offen offset:0 lds
    v_cvt_pk_bf16_f32 v129, v101, v100
    buffer_load_dwordx4 v9, s[4:7], s70 offen offset:1024 lds
    v_cvt_pk_bf16_f32 v130, v99, v98
    buffer_load_dwordx4 v10, s[4:7], s70 offen offset:2048 lds
    v_cvt_pk_bf16_f32 v131, v97, v96
    buffer_load_dwordx4 v11, s[4:7], s70 offen offset:3072 lds
    v_cvt_pk_bf16_f32 v146, v106, v106
    v_cvt_pk_bf16_f32 v147, v105, v105
    s_add_u32 m0, s73, 4096
    v_cvt_pk_bf16_f32 v148, v105, v104
    buffer_load_dwordx4 v12, s[4:7], s70 offen offset:0 lds
    v_cvt_pk_bf16_f32 v149, v104, v104
    buffer_load_dwordx4 v13, s[4:7], s70 offen offset:1024 lds
    v_and_b32 v5, 1, v2
    v_cmp_eq_u32 vcc, 1, v5
    s_nop 1
    v_cndmask_b32 v5, v107, v108, vcc
    v_cvt_pk_bf16_f32 v165, v108, v5
    s_add_u32 m0, s74, 0
    s_cmp_eq_u32 s60, 1
    s_cbranch_scc0 L_c_13
    s_waitcnt lgkmcnt(0)
    buffer_store_dwordx4 v[36:39], v251, s[16:19], s75 offen offset:0 sc1
    buffer_store_dwordx4 v[40:43], v251, s[16:19], s75 offen offset:1024 sc1
    buffer_store_dwordx4 v[44:47], v251, s[16:19], s75 offen offset:2048 sc1
L_c_13:
    v_cvt_pk_bf16_f32 v164, v108, v108
    buffer_load_dwordx4 v16, s[8:11], s71 offen lds
    v_cvt_pk_bf16_f32 v166, v107, v107
    s_add_u32 s70, s70, 128
    s_cmp_eq_u32 s70, 1280
    s_cselect_b32 s70, 0, s70
    v_cvt_pk_bf16_f32 v167, v107, v107
    buffer_load_dwordx4 v17, s[8:11], s71 offen offset:1024 lds
    v_and_b32 v5, 1, v2
    v_cmp_eq_u32 vcc, 1, v5
    s_nop 1
    v_cndmask_b32 v5, v109, v110, vcc
    v_cvt_pk_bf16_f32 v183, v110, v5
    s_add_u32 m0, s74, 8192
    v_cvt_pk_bf16_f32 v182, v110, v110
    v_cvt_pk_bf16_f32 v184, v109, v109
    buffer_load_dwordx4 v16, s[12:15], s71 offen lds
    buffer_load_dwordx4 v17, s[12:15], s71 offen offset:1024 lds
    s_waitcnt vmcnt(10)
    v_cmp_ne_u32 vcc, 1, v255
    s_nop 0
    s_or_b32 s92, vcc_lo, vcc_hi
    s_cbranch_scc0 L_ok_14
    s_mov_b32 s90, 0
L_poll_15:
    buffer_load_dword v255, v254, s[28:31], 0 offen sc1
    s_waitcnt vmcnt(0)
    v_cmp_ne_u32 vcc, 1, v255
    s_nop 0
    s_or_b32 s92, vcc_lo, vcc_hi
    s_cbranch_scc0 L_pdone_16
    s_sleep 4
    s_add_u32 s90, s90, 1
    s_cmp_lt_u32 s90, 40000
    s_cbranch_scc1 L_poll_15
L_pdone_16:
L_ok_14:
    s_barrier
    s_cmp_eq_u32 s60, 2
    s_cbranch_scc0 L_c_17
    v_add_u32 v3, 81920, v249
    v_add_u32 v4, 81920, v250
    ds_read_b64_tr_b16 v[36:37], v3 offset:0
    ds_read_b64_tr_b16 v[38:39], v4 offset:0
    ds_read_b64_tr_b16 v[40:41], v3 offset:4096
    ds_read_b64_tr_b16 v[42:43], v4 offset:4096
    ds_read_b64_tr_b16 v[44:45], v3 offset:8192
    ds_read_b64_tr_b16 v[46:47], v4 offset:8192
L_c_17:
    s_add_u32 m0, s73, 40960
    s_mul_i32 s71, s70, 1728
    v_cvt_pk_bf16_f32 v185, v109, v109
    buffer_load_dwordx4 v8, s[4:7], s70 offen offset:0 lds
    v_mov_b32_dpp v132, v128 wave_shr:1 row_mask:0xf bank_mask:0xf bound_ctrl:0
    buffer_load_dwordx4 v9, s[4:7], s70 offen offset:1024 lds
    v_mov_b32_dpp v133, v129 wave_shr:1 row_mask:0xf bank_mask:0xf bound_ctrl:0
    buffer_load_dwordx4 v10, s[4:7], s70 offen offset:2048 lds
    v_mov_b32 v142, v129
    v_mov_b32 v143, v130
    buffer_load_dwordx4 v11, s[4:7], s70 offen offset:3072 lds
    v_mov_b32 v144, v131
    s_add_u32 m0, s73, 45056
    v_alignbit_b32 v134, v129, v128, 16
    buffer_load_dwordx4 v12, s[4:7], s70 offen offset:0 lds
    v_alignbit_b32 v135, v130, v129, 16
    v_alignbit_b32 v136, v131, v130, 16
    buffer_load_dwordx4 v13, s[4:7], s70 offen offset:1024 lds
    v_alignbit_b32 v137, v132, v131, 16
    s_add_u32 m0, s74, 40960
    s_cmp_eq_u32 s60, 2
    s_cbranch_scc0 L_c_18
    s_waitcnt lgkmcnt(0)
    buffer_store_dwordx4 v[36:39], v251, s[16:19], s75 offen offset:0 sc1
    buffer_store_dwordx4 v[40:43], v251, s[16:19], s75 offen offset:1024 sc1
    buffer_store_dwordx4 v[44:47], v251, s[16:19], s75 offen offset:2048 sc1
L_c_18:
    buffer_load_dwordx4 v16, s[8:11], s71 offen lds
    v_alignbit_b32 v138, v130, v129, 16
    v_alignbit_b32 v139, v131, v130, 16
    s_add_u32 s70, s70, 128
    s_cmp_eq_u32 s70, 1280
    s_cselect_b32 s70, 0, s70
    v_alignbit_b32 v140, v132, v131, 16
    buffer_load_dwordx4 v17, s[8:11], s71 offen offset:1024 lds
    v_alignbit_b32 v141, v133, v132, 16
    s_add_u32 m0, s74, 49152
    v_mov_b32 v145, v132
    v_mov_b32_dpp v150, v128 wave_ror:1 row_mask:0xf bank_mask:0xf
    buffer_load_dwordx4 v16, s[12:15], s71 offen lds
    buffer_load_dwordx4 v17, s[12:15], s71 offen offset:1024 lds
    s_waitcnt vmcnt(10)
    s_barrier
    s_cmp_eq_u32 s60, 3
    s_cbranch_scc0 L_c_19
    v_add_u32 v3, 0, v249
    v_add_u32 v4, 0, v250
    ds_read_b64_tr_b16 v[36:37], v3 offset:0
    ds_read_b64_tr_b16 v[38:39], v4 offset:0
    ds_read_b64_tr_b16 v[40:41], v3 offset:4096
    ds_read_b64_tr_b16 v[42:43], v4 offset:4096
    ds_read_b64_tr_b16 v[44:45], v3 offset:8192
    ds_read_b64_tr_b16 v[46:47], v4 offset:8192
L_c_19:
    s_add_u32 m0, s73, 81920
    s_mul_i32 s71, s70, 1728
    v_mov_b32_dpp v151, v129 wave_ror:1 row_mask:0xf bank_mask:0xf
    buffer_load_dwordx4 v8, s[4:7], s70 offen offset:0 lds
    v_mov_b32 v160, v147
    buffer_load_dwordx4 v9, s[4:7], s70 offen offset:1024 lds
    v_mov_b32 v161, v148
    buffer_load_dwordx4 v10, s[4:7], s70 offen offset:2048 lds
    v_mov_b32 v162, v149
    v_mov_b32_dpp v150, v146 wave_shr:1 row_mask:0xf bank_mask:0xf
    buffer_load_dwordx4 v11, s[4:7], s70 offen offset:3072 lds
    v_mov_b32_dpp v151, v147 wave_shr:1 row_mask:0xf bank_mask:0xf
    s_add_u32 m0, s73, 86016
    v_alignbit_b32 v152, v147, v146, 16
    buffer_load_dwordx4 v12, s[4:7], s70 offen offset:0 lds
    v_alignbit_b32 v153, v148, v147, 16
    v_alignbit_b32 v154, v149, v148, 16
    buffer_load_dwordx4 v13, s[4:7], s70 offen offset:1024 lds
    v_alignbit_b32 v155, v150, v149, 16
    s_add_u32 m0, s74, 81920
    s_cmp_eq_u32 s60, 3
    s_cbranch_scc0 L_c_20
    s_waitcnt lgkmcnt(0)
    buffer_store_dwordx4 v[36:39], v251, s[16:19], s75 offen offset:0 sc1
    buffer_store_dwordx4 v[40:43], v251, s[16:19], s75 offen offset:1024 sc1
    buffer_store_dwordx4 v[44:47], v251, s[16:19], s75 offen offset:2048 sc1
L_c_20:
    buffer_load_dwordx4 v16, s[8:11], s71 offen lds
    v_alignbit_b32 v156, v148, v147, 16
    v_alignbit_b32 v157, v149, v148, 16
    s_add_u32 s70, s70, 128
    s_cmp_eq_u32 s70, 1280
    s_cselect_b32 s70, 0, s70
    v_alignbit_b32 v158, v150, v149, 16
    buffer_load_dwordx4 v17, s[8:11], s71 offen offset:1024 lds
    v_alignbit_b32 v159, v151, v150, 16
    s_add_u32 m0, s74, 90112
    v_mov_b32 v163, v150
    v_mov_b32_dpp v168, v146 wave_ror:1 row_mask:0xf bank_mask:0xf
    buffer_load_dwordx4 v16, s[12:15], s71 offen lds
    buffer_load_dwordx4 v17, s[12:15], s71 offen offset:1024 lds
    s_waitcnt vmcnt(10)
    s_barrier
    s_cmp_eq_u32 s60, 4
    s_cbranch_scc0 L_c_21
    v_add_u32 v3, 40960, v249
    v_add_u32 v4, 40960, v250
    ds_read_b64_tr_b16 v[36:37], v3 offset:0
    ds_read_b64_tr_b16 v[38:39], v4 offset:0
    ds_read_b64_tr_b16 v[40:41], v3 offset:4096
    ds_read_b64_tr_b16 v[42:43], v4 offset:4096
    ds_read_b64_tr_b16 v[44:45], v3 offset:8192
    ds_read_b64_tr_b16 v[46:47], v4 offset:8192
L_c_21:
    s_add_u32 m0, s73, 0
    s_mul_i32 s71, s70, 1728
    v_mov_b32_dpp v169, v147 wave_ror:1 row_mask:0xf bank_mask:0xf
    buffer_load_dwordx4 v8, s[4:7], s70 offen offset:0 lds
    v_mov_b32 v178, v165
    buffer_load_dwordx4 v9, s[4:7], s70 offen offset:1024 lds
    v_mov_b32 v179, v166
    buffer_load_dwordx4 v10, s[4:7], s70 offen offset:2048 lds
    v_mov_b32 v180, v167
    v_mov_b32_dpp v168, v164 wave_shr:1 row_mask:0xf bank_mask:0xf
    buffer_load_dwordx4 v11, s[4:7], s70 offen offset:3072 lds
    v_mov_b32_dpp v169, v165 wave_shr:1 row_mask:0xf bank_mask:0xf
    s_add_u32 m0, s73, 4096
    v_alignbit_b32 v170, v165, v164, 16
    buffer_load_dwordx4 v12, s[4:7], s70 offen offset:0 lds
    v_alignbit_b32 v171, v166, v165, 16
    v_alignbit_b32 v172, v167, v166, 16
    buffer_load_dwordx4 v13, s[4:7], s70 offen offset:1024 lds
    v_alignbit_b32 v173, v168, v167, 16
    s_add_u32 m0, s74, 0
    s_cmp_eq_u32 s60, 4
    s_cbranch_scc0 L_c_22
    s_waitcnt lgkmcnt(0)
    buffer_store_dwordx4 v[36:39], v251, s[16:19], s75 offen offset:0 sc1
    buffer_store_dwordx4 v[40:43], v251, s[16:19], s75 offen offset:1024 sc1
    buffer_store_dwordx4 v[44:47], v251, s[16:19], s75 offen offset:2048 sc1
L_c_22:
    buffer_load_dwordx4 v16, s[8:11], s71 offen lds
    v_alignbit_b32 v174, v166, v165, 16
    v_alignbit_b32 v175, v167, v166, 16
    s_add_u32 s70, s70, 128
    s_cmp_eq_u32 s70, 1280
    s_cselect_b32 s70, 0, s70
    v_alignbit_b32 v176, v168, v167, 16
    buffer_load_dwordx4 v17, s[8:11], s71 offen offset:1024 lds
    v_alignbit_b32 v177, v169, v168, 16
    s_add_u32 m0, s74, 8192
    v_mov_b32 v181, v168
    v_mov_b32_dpp v186, v164 wave_ror:1 row_mask:0xf bank_mask:0xf
    buffer_load_dwordx4 v16, s[12:15], s71 offen lds
    buffer_load_dwordx4 v17, s[12:15], s71 offen offset:1024 lds
    s_waitcnt vmcnt(10)
    s_barrier
    s_add_u32 m0, s73, 40960
    s_mul_i32 s71, s70, 1728
    v_mov_b32_dpp v187, v165 wave_ror:1 row_mask:0xf bank_mask:0xf
    buffer_load_dwordx4 v8, s[4:7], s70 offen offset:0 lds
    v_mov_b32 v196, v183
    v_mov_b32 v197, v184
    buffer_load_dwordx4 v9, s[4:7], s70 offen offset:1024 lds
    v_mov_b32 v198, v185
    buffer_load_dwordx4 v10, s[4:7], s70 offen offset:2048 lds
    v_mov_b32_dpp v186, v182 wave_shr:1 row_mask:0xf bank_mask:0xf
    v_mov_b32_dpp v187, v183 wave_shr:1 row_mask:0xf bank_mask:0xf
    buffer_load_dwordx4 v11, s[4:7], s70 offen offset:3072 lds
    v_alignbit_b32 v188, v183, v182, 16
    v_alignbit_b32 v189, v184, v183, 16
    s_add_u32 m0, s73, 45056
    v_alignbit_b32 v190, v185, v184, 16
    buffer_load_dwordx4 v12, s[4:7], s70 offen offset:0 lds
    v_alignbit_b32 v191, v186, v185, 16
    v_alignbit_b32 v192, v184, v183, 16
    buffer_load_dwordx4 v13, s[4:7], s70 offen offset:1024 lds
    v_alignbit_b32 v193, v185, v184, 16
    s_add_u32 m0, s74, 40960
    v_alignbit_b32 v194, v186, v185, 16
    v_alignbit_b32 v195, v187, v186, 16
    buffer_load_dwordx4 v16, s[8:11], s71 offen lds
    v_mov_b32 v199, v186
    s_mul_i32 s80, s58, 5
    s_add_u32 s70, s70, 128
    s_cmp_eq_u32 s70, 1280
    s_cselect_b32 s70, 0, s70
    s_lshr_b32 s80, s80, 2
    buffer_load_dwordx4 v17, s[8:11], s71 offen offset:1024 lds
    s_lshl_b32 s80, s80, 8
    s_add_u32 s80, s80, 5120
    s_add_u32 m0, s74, 49152
    v_min_u32 v228, 53, v2
    v_lshlrev_b32 v228, 2, v228
    buffer_load_dwordx4 v16, s[12:15], s71 offen lds
    buffer_load_dwordx4 v17, s[12:15], s71 offen offset:1024 lds
    s_waitcnt vmcnt(10)
    s_barrier
    s_add_u32 m0, s73, 81920
    s_mul_i32 s71, s70, 1728
    v_add_u32 v218, s80, v228
    buffer_load_dwordx4 v8, s[4:7], s70 offen offset:0 lds
    s_mul_i32 s69, s58, 276480
    s_and_b32 s80, s56, 1
    buffer_load_dwordx4 v9, s[4:7], s70 offen offset:1024 lds
    s_mul_i32 s80, s80, 5120
    buffer_load_dwordx4 v10, s[4:7], s70 offen offset:2048 lds
    s_add_u32 s69, s69, s80
    s_add_u32 s69, s69, 5505024
    buffer_load_dwordx4 v11, s[4:7], s70 offen offset:3072 lds
    s_lshr_b32 s82, s56, 1
    s_mul_i32 s83, s82, 51200
    s_add_u32 m0, s73, 86016
    s_add_u32 s89, s83, s69
    buffer_load_dwordx4 v12, s[4:7], s70 offen offset:0 lds
    s_mul_i32 s82, s82, 10240
    s_add_u32 s69, s69, s82
    buffer_load_dwordx4 v13, s[4:7], s70 offen offset:1024 lds
    s_and_b32 s80, s57, 15
    s_mul_i32 s80, s80, 11
    s_lshr_b32 s80, s80, 5
    s_min_u32 s80, s80, 4
    s_add_u32 m0, s74, 81920
    s_add_u32 s81, s80, 1
    s_cmp_ge_u32 s81, 5
    s_cselect_b32 s93, 5, 0
    s_sub_u32 s81, s81, s93
    s_mul_i32 s81, s81, 10240
    s_add_u32 s64, s81, s89
    s_add_u32 s81, s80, 2
    s_cmp_ge_u32 s81, 5
    s_cselect_b32 s93, 5, 0
    s_sub_u32 s81, s81, s93
    s_mul_i32 s81, s81, 10240
    s_add_u32 s65, s81, s89
    buffer_load_dwordx4 v16, s[8:11], s71 offen lds
    s_add_u32 s81, s80, 3
    s_cmp_ge_u32 s81, 5
    s_cselect_b32 s93, 5, 0
    s_sub_u32 s81, s81, s93
    s_mul_i32 s81, s81, 10240
    s_add_u32 s66, s81, s89
    s_add_u32 s81, s80, 4
    s_cmp_ge_u32 s81, 5
    s_cselect_b32 s93, 5, 0
    s_sub_u32 s81, s81, s93
    s_mul_i32 s81, s81, 10240
    s_add_u32 s67, s81, s89
    s_add_u32 s70, s70, 128
    s_cmp_eq_u32 s70, 1280
    s_cselect_b32 s70, 0, s70
    s_add_u32 s81, s80, 5
    s_cmp_ge_u32 s81, 5
    s_cselect_b32 s93, 5, 0
    s_sub_u32 s81, s81, s93
    s_mul_i32 s81, s81, 10240
    s_add_u32 s68, s81, s89
    buffer_load_dwordx4 v17, s[8:11], s71 offen offset:1024 lds
    s_lshr_b32 s81, s55, 2
    s_lshl_b32 s81, s81, 7
    s_add_u32 m0, s74, 90112
    v_min_u32 v228, 19, v2
    v_lshlrev_b32 v228, 2, v228
    buffer_load_dwordx4 v16, s[12:15], s71 offen lds
    buffer_load_dwordx4 v17, s[12:15], s71 offen offset:1024 lds
    s_waitcnt vmcnt(10)
    s_barrier
    buffer_load_dword v219, v218, s[16:19], 0 offen sc1
    buffer_load_dword v220, v218, s[16:19], 0 offen offset:256 sc1
    s_add_u32 m0, s73, 0
    s_mul_i32 s71, s70, 1728
    v_add_u32 v216, s81, v228
    buffer_load_dwordx4 v8, s[4:7], s70 offen offset:0 lds
    s_mul_i32 s81, s56, 4160
    s_add_u32 s81, s81, 98096
    buffer_load_dwordx4 v9, s[4:7], s70 offen offset:1024 lds
    v_sub_u32 v221, s81, v1
    buffer_load_dwordx4 v10, s[4:7], s70 offen offset:2048 lds
    s_mul_i32 s81, s56, 4608
    s_add_u32 s81, s81, 61952
    buffer_load_dwordx4 v11, s[4:7], s70 offen offset:3072 lds
    v_add_u32 v222, s81, v1
    v_mov_b64 v[224:225], 0
    s_add_u32 m0, s73, 4096
    v_mov_b64 v[226:227], 0
    buffer_load_dwordx4 v12, s[4:7], s70 offen offset:0 lds
    s_and_b32 s81, s55, 3
    s_lshl_b32 s81, s81, 2
    buffer_load_dwordx4 v13, s[4:7], s70 offen offset:1024 lds
    s_add_u32 s81, s81, s56
    s_add_u32 m0, s74, 0
    s_lshl_b32 s81, s81, 6
    s_lshr_b32 s82, s55, 2
    buffer_load_dwordx4 v16, s[8:11], s71 offen lds
    s_lshl_b32 s82, s82, 16
    s_add_u32 s81, s81, s82
    s_add_u32 s32, s81, 65536
    buffer_load_dwordx4 v17, s[8:11], s71 offen offset:1024 lds
    v_lshrrev_b32 v228, 2, v2
    v_lshlrev_b32 v228, 10, v228
    s_add_u32 m0, s74, 8192
    v_and_b32 v223, 3, v2
    v_lshl_add_u32 v223, v223, 4, v228
    buffer_load_dwordx4 v16, s[12:15], s71 offen lds
    buffer_load_dwordx4 v17, s[12:15], s71 offen offset:1024 lds
    v_add_u32 v16, 4096, v1
    s_waitcnt vmcnt(12)
    s_barrier
    buffer_load_dword v217, v216, s[16:19], 0 offen sc1
    s_waitcnt vmcnt(11)
    v_and_b32 v219, v219, v220
    v_cmp_ne_u32 vcc, 1, v219
    s_nop 0
    s_or_b32 s92, vcc_lo, vcc_hi
    s_cbranch_scc0 L_ok_23
    s_mov_b32 s90, 0
L_poll_24:
    buffer_load_dword v219, v218, s[16:19], 0 offen sc1
    buffer_load_dword v220, v218, s[16:19], 0 offen offset:256 sc1
    s_waitcnt vmcnt(0)
    v_and_b32 v219, v219, v220
    v_cmp_ne_u32 vcc, 1, v219
    s_nop 0
    s_or_b32 s92, vcc_lo, vcc_hi
    s_cbranch_scc0 L_pdone_25
    s_sleep 4
    s_add_u32 s90, s90, 1
    s_cmp_lt_u32 s90, 40000
    s_cbranch_scc1 L_poll_24
L_pdone_25:
L_ok_23:
    s_add_u32 s87, s65, 102400
    buffer_load_dwordx4 v[36:39], v1, s[16:19], s87 offen offset:0 sc1
    ds_write_b128 v221, v[128:131] offset:53184
    buffer_load_dwordx4 v[40:43], v1, s[16:19], s87 offen offset:1024 sc1
    ds_write_b128 v221, v[146:149] offset:52160
    buffer_load_dwordx4 v[44:47], v1, s[16:19], s87 offen offset:2048 sc1
    ds_write_b128 v221, v[164:167] offset:51136
    ds_write_b128 v221, v[182:185] offset:50112
    buffer_load_dwordx4 v[48:51], v1, s[16:19], s87 offen offset:3072 sc1
    ds_write_b128 v221, v[134:137] offset:36480
    buffer_load_dwordx4 v[52:55], v16, s[16:19], s87 offen offset:0 sc1
    ds_write_b128 v221, v[152:155] offset:35456
    ds_write_b128 v221, v[170:173] offset:34432
    s_add_u32 s87, s66, 0
    buffer_load_dwordx4 v[56:59], v1, s[16:19], s87 offen offset:0 sc1
    ds_write_b128 v221, v[188:191] offset:33408
    s_waitcnt vmcnt(7)
    s_barrier
    s_waitcnt vmcnt(6)
    v_cmp_ne_u32 vcc, 1, v217
    s_nop 0
    s_or_b32 s92, vcc_lo, vcc_hi
    s_cbranch_scc0 L_ok_26
    s_mov_b32 s90, 0
L_poll_27:
    buffer_load_dword v217, v216, s[16:19], 0 offen sc1
    s_waitcnt vmcnt(0)
    v_cmp_ne_u32 vcc, 1, v217
    s_nop 0
    s_or_b32 s92, vcc_lo, vcc_hi
    s_cbranch_scc0 L_pdone_28
    s_sleep 4
    s_add_u32 s90, s90, 1
    s_cmp_lt_u32 s90, 40000
    s_cbranch_scc1 L_poll_27
L_pdone_28:
L_ok_26:
    buffer_load_dwordx4 v[200:203], v223, s[16:19], s32 offen sc1
    s_add_u32 s32, s32, 16384
    buffer_load_dwordx4 v[204:207], v223, s[16:19], s32 offen sc1
    s_add_u32 s32, s32, 16384
    buffer_load_dwordx4 v[208:211], v223, s[16:19], s32 offen sc1
    s_add_u32 s32, s32, 16384
    buffer_load_dwordx4 v[212:215], v223, s[16:19], s32 offen sc1
    ds_write_b128 v221, v[138:141] offset:3072
    ds_write_b128 v221, v[156:159] offset:2048
    ds_write_b128 v221, v[174:177] offset:1024
    ds_write_b128 v221, v[192:195] offset:0
    ds_write_b128 v221, v[142:145] offset:19776
    ds_write_b128 v221, v[160:163] offset:18752
    s_add_u32 s87, s66, 0
    buffer_load_dwordx4 v[60:63], v1, s[16:19], s87 offen offset:1024 sc1
    ds_write_b128 v221, v[178:181] offset:17728
    ds_write_b128 v221, v[196:199] offset:16704
    v_bfe_u32 v3, v2, 1, 2
    v_mul_u32_u24 v3, 16704, v3
    buffer_load_dwordx4 v[64:67], v1, s[16:19], s87 offen offset:2048 sc1
    v_and_b32 v4, 1, v2
    v_lshlrev_b32 v4, 4, v4
    s_mul_i32 s80, s56, 4160
    s_add_u32 s80, s80, 101184
    v_add3_u32 v3, v3, v4, s80
    buffer_load_dwordx4 v[68:71], v1, s[16:19], s87 offen offset:3072 sc1
    ds_write_b128 v3, v[224:227]
    v_and_b32 v4, 0x1f0, v1
    v_sub_u32 v4, v4, v1
    v_add_u32 v4, v4, v222
    v_subrev_u32 v4, 512, v4
    s_waitcnt vmcnt(12)
    buffer_load_dwordx4 v[72:75], v16, s[16:19], s87 offen offset:0 sc1
    ds_write_b128 v4, v[224:227]
    s_waitcnt vmcnt(4)
    ds_write_b128 v222, v[200:203] offset:0
    ds_write_b128 v222, v[204:207] offset:1024
    ds_write_b128 v222, v[208:211] offset:2048
    ds_write_b128 v222, v[212:215] offset:3072
    s_add_u32 s87, s66, 102400
    buffer_load_dwordx4 v[76:79], v1, s[16:19], s87 offen offset:0 sc1
    buffer_load_dwordx4 v[80:83], v1, s[16:19], s87 offen offset:1024 sc1
    s_waitcnt lgkmcnt(0)
    s_barrier
    s_mul_i32 s82, s56, 5120
    s_add_u32 s80, s64, 0
    s_add_u32 m0, s82, 0
    s_nop 0
    buffer_load_dwordx4 v1, s[16:19], s80 offen offset:0 sc1 lds
    buffer_load_dwordx4 v1, s[16:19], s80 offen offset:1024 sc1 lds
    buffer_load_dwordx4 v1, s[16:19], s80 offen offset:2048 sc1 lds
    buffer_load_dwordx4 v1, s[16:19], s80 offen offset:3072 sc1 lds
    s_add_u32 m0, s82, 4096
    s_nop 0
    buffer_load_dwordx4 v16, s[16:19], s80 offen sc1 lds
    s_add_u32 s80, s64, 102400
    s_add_u32 m0, s82, 20480
    s_nop 0
    buffer_load_dwordx4 v1, s[16:19], s80 offen offset:0 sc1 lds
    buffer_load_dwordx4 v1, s[16:19], s80 offen offset:1024 sc1 lds
    s_waitcnt vmcnt(12)
    buffer_load_dwordx4 v1, s[16:19], s80 offen offset:2048 sc1 lds
    s_waitcnt vmcnt(12)
    buffer_load_dwordx4 v1, s[16:19], s80 offen offset:3072 sc1 lds
    s_add_u32 m0, s82, 24576
    s_waitcnt vmcnt(12)
    buffer_load_dwordx4 v16, s[16:19], s80 offen sc1 lds
    s_add_u32 s80, s65, 0
    s_add_u32 m0, s82, 40960
    s_waitcnt vmcnt(12)
    buffer_load_dwordx4 v1, s[16:19], s80 offen offset:0 sc1 lds
    s_waitcnt vmcnt(12)
    buffer_load_dwordx4 v1, s[16:19], s80 offen offset:1024 sc1 lds
    s_waitcnt vmcnt(12)
    buffer_load_dwordx4 v1, s[16:19], s80 offen offset:2048 sc1 lds
    s_waitcnt vmcnt(12)
    buffer_load_dwordx4 v1, s[16:19], s80 offen offset:3072 sc1 lds
    s_add_u32 m0, s82, 45056
    s_waitcnt vmcnt(12)
    buffer_load_dwordx4 v16, s[16:19], s80 offen sc1 lds
    s_add_u32 s87, s66, 102400
    s_waitcnt vmcnt(12)
    buffer_load_dwordx4 v[84:87], v1, s[16:19], s87 offen offset:2048 sc1
    s_waitcnt vmcnt(12)
    buffer_load_dwordx4 v[88:91], v1, s[16:19], s87 offen offset:3072 sc1
    s_waitcnt vmcnt(12)
    buffer_load_dwordx4 v[92:95], v16, s[16:19], s87 offen offset:0 sc1
    s_add_u32 s87, s67, 0
    s_waitcnt vmcnt(12)
    buffer_load_dwordx4 v[96:99], v1, s[16:19], s87 offen offset:0 sc1
    s_waitcnt vmcnt(12)
    buffer_load_dwordx4 v[100:103], v1, s[16:19], s87 offen offset:1024 sc1
    s_waitcnt vmcnt(12)
    buffer_load_dwordx4 v[104:107], v1, s[16:19], s87 offen offset:2048 sc1
    s_waitcnt vmcnt(12)
    buffer_load_dwordx4 v[108:111], v1, s[16:19], s87 offen offset:3072 sc1
    s_waitcnt vmcnt(12)
    buffer_load_dwordx4 v[112:115], v16, s[16:19], s87 offen offset:0 sc1
    s_add_u32 s87, s67, 102400
    s_waitcnt vmcnt(12)
    buffer_load_dwordx4 v[116:119], v1, s[16:19], s87 offen offset:0 sc1
    s_waitcnt vmcnt(12)
    buffer_load_dwordx4 v[120:123], v1, s[16:19], s87 offen offset:1024 sc1
    s_waitcnt vmcnt(12)
    buffer_load_dwordx4 v[124:127], v1, s[16:19], s87 offen offset:2048 sc1
    s_waitcnt vmcnt(12)
    buffer_load_dwordx4 v[128:131], v1, s[16:19], s87 offen offset:3072 sc1
    s_waitcnt vmcnt(12)
    buffer_load_dwordx4 v[132:135], v16, s[16:19], s87 offen offset:0 sc1
    s_add_u32 s87, s68, 0
    s_waitcnt vmcnt(12)
    buffer_load_dwordx4 v[136:139], v1, s[16:19], s87 offen offset:0 sc1
    s_waitcnt vmcnt(12)
    buffer_load_dwordx4 v[140:143], v1, s[16:19], s87 offen offset:1024 sc1
    s_waitcnt vmcnt(12)
    buffer_load_dwordx4 v[144:147], v1, s[16:19], s87 offen offset:2048 sc1
    s_waitcnt vmcnt(12)
    buffer_load_dwordx4 v[148:151], v1, s[16:19], s87 offen offset:3072 sc1
    s_waitcnt vmcnt(12)
    buffer_load_dwordx4 v[152:155], v16, s[16:19], s87 offen offset:0 sc1
    s_add_u32 s87, s68, 102400
    s_waitcnt vmcnt(12)
    buffer_load_dwordx4 v[156:159], v1, s[16:19], s87 offen offset:0 sc1
    s_waitcnt vmcnt(12)
    buffer_load_dwordx4 v[160:163], v1, s[16:19], s87 offen offset:1024 sc1
    s_waitcnt vmcnt(12)
    buffer_load_dwordx4 v[164:167], v1, s[16:19], s87 offen offset:2048 sc1
    s_waitcnt vmcnt(12)
    buffer_load_dwordx4 v[168:171], v1, s[16:19], s87 offen offset:3072 sc1
    s_waitcnt vmcnt(12)
    buffer_load_dwordx4 v[172:175], v16, s[16:19], s87 offen offset:0 sc1
    s_add_u32 s87, s69, 204800
    s_waitcnt vmcnt(12)
    buffer_load_dwordx4 v[176:179], v1, s[16:19], s87 offen offset:0 sc1
    s_waitcnt vmcnt(12)
    buffer_load_dwordx4 v[180:183], v1, s[16:19], s87 offen offset:1024 sc1
    s_waitcnt vmcnt(12)
    buffer_load_dwordx4 v[184:187], v1, s[16:19], s87 offen offset:2048 sc1
    s_waitcnt vmcnt(12)
    buffer_load_dwordx4 v[188:191], v1, s[16:19], s87 offen offset:3072 sc1
    s_waitcnt vmcnt(12)
    buffer_load_dwordx4 v[192:195], v16, s[16:19], s87 offen offset:0 sc1
    s_add_u32 s87, s69, 225280
    s_waitcnt vmcnt(12)
    buffer_load_dwordx4 v[196:199], v1, s[16:19], s87 offen offset:0 sc1
    s_waitcnt vmcnt(12)
    buffer_load_dwordx4 v[200:203], v1, s[16:19], s87 offen offset:1024 sc1
    s_waitcnt vmcnt(12)
    buffer_load_dwordx4 v[204:207], v1, s[16:19], s87 offen offset:2048 sc1
    s_waitcnt vmcnt(12)
    buffer_load_dwordx4 v[208:211], v1, s[16:19], s87 offen offset:3072 sc1
    s_waitcnt vmcnt(12)
    buffer_load_dwordx4 v[212:215], v16, s[16:19], s87 offen offset:0 sc1
    s_branch L_help_g2
L_help_large:
    v_lshrrev_b32 v3, 3, v2
    v_and_b32 v4, 7, v2
    v_lshrrev_b32 v5, 4, v2
    v_xor_b32 v5, v4, v5
    v_lshlrev_b32 v5, 4, v5
    s_mul_i32 s80, s56, 64
    s_add_u32 s80, s80, s53
    s_mul_i32 s80, s80, 1280
    v_mul_u32_u24 v6, 1280, v3
    v_add3_u32 v8, v6, v5, s80
    v_xor_b32 v9, 64, v8
    v_add_u32 v10, 18432, v8
    v_add_u32 v11, 27648, v9
    v_add_u32 v12, 40960, v8
    v_add_u32 v13, 50176, v9
    v_add_u32 v14, 59392, v8
    v_add_u32 v15, 68608, v9
    v_add_u32 v9, 9216, v9
    v_bfe_u32 v5, v2, 4, 1
    v_lshlrev_b32 v5, 2, v5
    v_xor_b32 v5, v4, v5
    v_lshlrev_b32 v5, 4, v5
    s_mul_i32 s80, s56, 55296
    s_lshl_b32 s81, s52, 7
    s_add_u32 s80, s80, s81
    v_mul_u32_u24 v6, 3456, v3
    v_add3_u32 v16, v6, v5, s80
    v_add_u32 v17, 26624, v16
    s_mul_i32 s73, s56, 8192
    s_lshl_b32 s74, s56, 11
    s_add_u32 s74, s74, 32768
    v_and_b32 v248, 15, v2
    v_lshlrev_b32 v248, 3, v248
    s_lshl_b32 s70, s59, 7
    s_add_u32 m0, s73, 0
    s_mul_i32 s71, s70, 1728
    buffer_load_dwordx4 v8, s[4:7], s70 offen offset:0 lds
    buffer_load_dwordx4 v9, s[4:7], s70 offen offset:1024 lds
    buffer_load_dwordx4 v10, s[4:7], s70 offen offset:2048 lds
    buffer_load_dwordx4 v11, s[4:7], s70 offen offset:3072 lds
    s_add_u32 m0, s73, 4096
    s_nop 0
    buffer_load_dwordx4 v12, s[4:7], s70 offen offset:0 lds
    buffer_load_dwordx4 v13, s[4:7], s70 offen offset:1024 lds
    buffer_load_dwordx4 v14, s[4:7], s70 offen offset:2048 lds
    buffer_load_dwordx4 v15, s[4:7], s70 offen offset:3072 lds
    s_add_u32 m0, s74, 0
    s_nop 0
    buffer_load_dwordx4 v16, s[8:11], s71 offen lds
    buffer_load_dwordx4 v17, s[8:11], s71 offen offset:1024 lds
    s_add_u32 m0, s74, 8192
    s_nop 0
    buffer_load_dwordx4 v16, s[12:15], s71 offen lds
    buffer_load_dwordx4 v17, s[12:15], s71 offen offset:1024 lds
    buffer_load_dwordx2 v[236:237], v248, s[48:51], s70 offen
    s_add_u32 s70, s70, 128
    s_cmp_eq_u32 s70, 1280
    s_cselect_b32 s70, 0, s70
    s_setprio 1
    v_min_u32 v254, 0, v2
    v_lshlrev_b32 v254, 2, v254
    s_max_i32 s80, s62, 0
    s_lshl_b32 s81, s56, 3
    s_add_u32 s80, s80, s81
    v_lshrrev_b32 v3, 4, v2
    v_add_u32 v3, s80, v3
    v_lshrrev_b32 v4, 1, v3
    v_lshrrev_b32 v5, 1, v2
    v_xor_b32 v4, v4, v5
    v_and_b32 v4, 7, v4
    v_lshlrev_b32 v4, 4, v4
    v_lshlrev_b32 v3, 7, v3
    v_and_b32 v5, 1, v2
    v_lshlrev_b32 v5, 3, v5
    v_add3_u32 v200, v3, v4, v5
    v_xor_b32 v3, 32, v200
    v_add_u32 v201, 512, v3
    v_add_u32 v202, 98304, v200
    v_add_u32 v203, 98304, v201
    v_mov_b32 v242, 0
    v_mov_b32 v243, 0
    s_add_u32 s80, s80, s53
    s_lshl_b32 s80, s80, 2
    s_add_u32 s80, s80, 10240
    s_cmp_ge_i32 s62, 0
    s_cselect_b32 s78, s80, 2146435072
    s_and_b32 s84, s61, 1
    s_mul_i32 s84, s84, 128
    v_lshrrev_b32 v228, 4, v2
    v_bfe_u32 v229, v2, 2, 2
    v_lshl_add_u32 v230, v228, 3, v229
    v_add_u32 v230, s84, v230
    v_lshlrev_b32 v230, 7, v230
    v_lshrrev_b32 v229, 1, v229
    v_and_b32 v231, 1, v228
    v_lshl_or_b32 v229, v231, 2, v229
    v_bfe_u32 v231, v2, 1, 1
    s_lshl_b32 s85, s56, 1
    v_or_b32 v231, s85, v231
    v_xor_b32 v229, v229, v231
    v_lshlrev_b32 v229, 4, v229
    v_and_b32 v231, 1, v2
    v_lshlrev_b32 v231, 3, v231
    v_add3_u32 v249, v230, v229, v231
    v_xor_b32 v229, 32, v249
    v_add_u32 v250, 512, v229
    v_and_b32 v229, 15, v2
    v_lshlrev_b32 v229, 6, v229
    v_lshl_add_u32 v251, v228, 4, v229
    s_add_u32 s85, s59, s60
    s_cmp_ge_u32 s85, 10
    s_cselect_b32 s86, 10, 0
    s_sub_u32 s85, s85, s86
    s_lshl_b32 s85, s85, 2
    s_add_u32 s85, s85, s56
    s_lshl_b32 s86, s85, 16
    s_add_u32 s84, s84, s53
    s_lshl_b32 s84, s84, 5
    s_add_u32 s86, s86, s84
    s_add_u32 s75, s86, 65536
    s_mul_i32 s80, s58, 5
    s_lshr_b32 s80, s80, 2
    s_lshl_b32 s80, s80, 8
    s_add_u32 s80, s80, 5120
    v_min_u32 v228, 53, v2
    v_lshlrev_b32 v228, 2, v228
    v_add_u32 v218, s80, v228
    s_mul_i32 s69, s58, 276480
    s_and_b32 s80, s56, 1
    s_mul_i32 s80, s80, 5120
    s_add_u32 s69, s69, s80
    s_add_u32 s69, s69, 5505024
    s_lshr_b32 s82, s56, 1
    s_mul_i32 s83, s82, 51200
    s_add_u32 s89, s83, s69
    s_mul_i32 s82, s82, 10240
    s_add_u32 s69, s69, s82
    s_and_b32 s80, s57, 15
    s_mul_i32 s80, s80, 11
    s_lshr_b32 s80, s80, 5
    s_min_u32 s80, s80, 4
    s_add_u32 s81, s80, 1
    s_cmp_ge_u32 s81, 5
    s_cselect_b32 s93, 5, 0
    s_sub_u32 s81, s81, s93
    s_mul_i32 s81, s81, 10240
    s_add_u32 s64, s81, s89
    s_add_u32 s81, s80, 2
    s_cmp_ge_u32 s81, 5
    s_cselect_b32 s93, 5, 0
    s_sub_u32 s81, s81, s93
    s_mul_i32 s81, s81, 10240
    s_add_u32 s65, s81, s89
    s_add_u32 s81, s80, 3
    s_cmp_ge_u32 s81, 5
    s_cselect_b32 s93, 5, 0
    s_sub_u32 s81, s81, s93
    s_mul_i32 s81, s81, 10240
    s_add_u32 s66, s81, s89
    s_add_u32 s81, s80, 4
    s_cmp_ge_u32 s81, 5
    s_cselect_b32 s93, 5, 0
    s_sub_u32 s81, s81, s93
    s_mul_i32 s81, s81, 10240
    s_add_u32 s67, s81, s89
    s_add_u32 s81, s80, 5
    s_cmp_ge_u32 s81, 5
    s_cselect_b32 s93, 5, 0
    s_sub_u32 s81, s81, s93
    s_mul_i32 s81, s81, 10240
    s_add_u32 s68, s81, s89
    s_add_u32 m0, s73, 49152
    s_mul_i32 s71, s70, 1728
    buffer_load_dwordx4 v8, s[4:7], s70 offen offset:0 lds
    buffer_load_dwordx4 v9, s[4:7], s70 offen offset:1024 lds
    buffer_load_dwordx4 v10, s[4:7], s70 offen offset:2048 lds
    buffer_load_dwordx4 v11, s[4:7], s70 offen offset:3072 lds
    s_add_u32 m0, s73, 53248
    s_nop 0
    buffer_load_dwordx4 v12, s[4:7], s70 offen offset:0 lds
    buffer_load_dwordx4 v13, s[4:7], s70 offen offset:1024 lds
    buffer_load_dwordx4 v14, s[4:7], s70 offen offset:2048 lds
    buffer_load_dwordx4 v15, s[4:7], s70 offen offset:3072 lds
    s_add_u32 m0, s74, 49152
    s_nop 0
    buffer_load_dwordx4 v16, s[8:11], s71 offen lds
    buffer_load_dwordx4 v17, s[8:11], s71 offen offset:1024 lds
    s_add_u32 m0, s74, 57344
    s_nop 0
    buffer_load_dwordx4 v16, s[12:15], s71 offen lds
    buffer_load_dwordx4 v17, s[12:15], s71 offen offset:1024 lds
    buffer_load_dwordx2 v[238:239], v248, s[48:51], s70 offen
    s_add_u32 s70, s70, 128
    s_cmp_eq_u32 s70, 1280
    s_cselect_b32 s70, 0, s70
    s_setprio 0
    s_waitcnt vmcnt(13)
    s_barrier
    ds_read_b64 v[204:205], v200 offset:0
    ds_read_b64 v[206:207], v201 offset:0
    s_cmp_eq_u32 s60, 0
    s_cbranch_scc0 L_c_29
    v_add_u32 v3, 0, v249
    v_add_u32 v4, 0, v250
    ds_read_b64_tr_b16 v[36:37], v3 offset:0
    ds_read_b64_tr_b16 v[38:39], v4 offset:0
    ds_read_b64_tr_b16 v[40:41], v3 offset:4096
    ds_read_b64_tr_b16 v[42:43], v4 offset:4096
    ds_read_b64_tr_b16 v[44:45], v3 offset:8192
    ds_read_b64_tr_b16 v[46:47], v4 offset:8192
    ds_read_b64_tr_b16 v[48:49], v3 offset:12288
    ds_read_b64_tr_b16 v[50:51], v4 offset:12288
L_c_29:
    buffer_load_dword v255, v254, s[28:31], 0 offen sc1
    s_add_u32 m0, s73, 98304
    s_mul_i32 s71, s70, 1728
    v_lshlrev_b32 v208, 16, v236
    v_and_b32 v236, 0xffff0000, v236
    buffer_load_dwordx4 v8, s[4:7], s70 offen offset:0 lds
    v_lshlrev_b32 v209, 16, v237
    v_and_b32 v237, 0xffff0000, v237
    s_waitcnt lgkmcnt(0)
    buffer_load_dwordx4 v9, s[4:7], s70 offen offset:1024 lds
    v_lshlrev_b32 v210, 16, v204
    v_and_b32 v204, 0xffff0000, v204
    buffer_load_dwordx4 v10, s[4:7], s70 offen offset:2048 lds
    v_mul_f32 v210, v210, v208
    v_mul_f32 v204, v204, v236
    v_cvt_pk_bf16_f32 v210, 0, v210
    buffer_load_dwordx4 v11, s[4:7], s70 offen offset:3072 lds
    v_cvt_pk_bf16_f32 v204, 0, v204
    v_add_f32 v242, v242, v210
    s_add_u32 m0, s73, 102400
    v_add_f32 v242, v242, v204
    v_lshlrev_b32 v210, 16, v205
    v_and_b32 v205, 0xffff0000, v205
    buffer_load_dwordx4 v12, s[4:7], s70 offen offset:0 lds
    v_mul_f32 v210, v210, v209
    v_mul_f32 v205, v205, v237
    buffer_load_dwordx4 v13, s[4:7], s70 offen offset:1024 lds
    v_cvt_pk_bf16_f32 v210, 0, v210
    v_cvt_pk_bf16_f32 v205, 0, v205
    v_add_f32 v242, v242, v210
    buffer_load_dwordx4 v14, s[4:7], s70 offen offset:2048 lds
    v_add_f32 v242, v242, v205
    v_lshlrev_b32 v210, 16, v206
    buffer_load_dwordx4 v15, s[4:7], s70 offen offset:3072 lds
    v_and_b32 v206, 0xffff0000, v206
    v_mul_f32 v210, v210, v208
    s_cmp_eq_u32 s60, 0
    s_cbranch_scc0 L_c_30
    s_waitcnt lgkmcnt(0)
    buffer_store_dwordx4 v[36:39], v251, s[16:19], s75 offen offset:0 sc1
    buffer_store_dwordx4 v[40:43], v251, s[16:19], s75 offen offset:1024 sc1
    buffer_store_dwordx4 v[44:47], v251, s[16:19], s75 offen offset:2048 sc1
    buffer_store_dwordx4 v[48:51], v251, s[16:19], s75 offen offset:3072 sc1
L_c_30:
    s_add_u32 m0, s74, 98304
    v_mul_f32 v206, v206, v236
    v_cvt_pk_bf16_f32 v210, 0, v210
    buffer_load_dwordx4 v16, s[8:11], s71 offen lds
    v_cvt_pk_bf16_f32 v206, 0, v206
    v_add_f32 v243, v243, v210
    v_add_f32 v243, v243, v206
    buffer_load_dwordx4 v17, s[8:11], s71 offen offset:1024 lds
    v_lshlrev_b32 v210, 16, v207
    v_and_b32 v207, 0xffff0000, v207
    s_add_u32 m0, s74, 106496
    v_mul_f32 v210, v210, v209
    v_mul_f32 v207, v207, v237
    v_cvt_pk_bf16_f32 v210, 0, v210
    buffer_load_dwordx4 v16, s[12:15], s71 offen lds
    v_cvt_pk_bf16_f32 v207, 0, v207
    v_add_f32 v243, v243, v210
    v_add_f32 v243, v243, v207
    buffer_load_dwordx4 v17, s[12:15], s71 offen offset:1024 lds
    buffer_load_dwordx2 v[240:241], v248, s[48:51], s70 offen
    s_add_u32 s70, s70, 128
    s_cmp_eq_u32 s70, 1280
    s_cselect_b32 s70, 0, s70
    s_waitcnt vmcnt(14)
    s_barrier
    ds_read_b64 v[204:205], v200 offset:49152
    ds_read_b64 v[206:207], v201 offset:49152
    s_add_u32 m0, s73, 0
    s_mul_i32 s71, s70, 1728
    v_lshlrev_b32 v208, 16, v238
    v_and_b32 v238, 0xffff0000, v238
    buffer_load_dwordx4 v8, s[4:7], s70 offen offset:0 lds
    v_lshlrev_b32 v209, 16, v239
    v_and_b32 v239, 0xffff0000, v239
    buffer_load_dwordx4 v9, s[4:7], s70 offen offset:1024 lds
    s_waitcnt lgkmcnt(0)
    v_lshlrev_b32 v210, 16, v204
    v_and_b32 v204, 0xffff0000, v204
    buffer_load_dwordx4 v10, s[4:7], s70 offen offset:2048 lds
    v_mul_f32 v210, v210, v208
    v_mul_f32 v204, v204, v238
    buffer_load_dwordx4 v11, s[4:7], s70 offen offset:3072 lds
    v_cvt_pk_bf16_f32 v210, 0, v210
    v_cvt_pk_bf16_f32 v204, 0, v204
    v_add_f32 v242, v242, v210
    s_add_u32 m0, s73, 4096
    v_add_f32 v242, v242, v204
    v_lshlrev_b32 v210, 16, v205
    buffer_load_dwordx4 v12, s[4:7], s70 offen offset:0 lds
    v_and_b32 v205, 0xffff0000, v205
    v_mul_f32 v210, v210, v209
    v_mul_f32 v205, v205, v239
    buffer_load_dwordx4 v13, s[4:7], s70 offen offset:1024 lds
    v_cvt_pk_bf16_f32 v210, 0, v210
    v_cvt_pk_bf16_f32 v205, 0, v205
    buffer_load_dwordx4 v14, s[4:7], s70 offen offset:2048 lds
    v_add_f32 v242, v242, v210
    v_add_f32 v242, v242, v205
    v_lshlrev_b32 v210, 16, v206
    buffer_load_dwordx4 v15, s[4:7], s70 offen offset:3072 lds
    v_and_b32 v206, 0xffff0000, v206
    v_mul_f32 v210, v210, v208
    s_add_u32 m0, s74, 0
    v_mul_f32 v206, v206, v238
    v_cvt_pk_bf16_f32 v210, 0, v210
    v_cvt_pk_bf16_f32 v206, 0, v206
    buffer_load_dwordx4 v16, s[8:11], s71 offen lds
    v_add_f32 v243, v243, v210
    v_add_f32 v243, v243, v206
    buffer_load_dwordx4 v17, s[8:11], s71 offen offset:1024 lds
    v_lshlrev_b32 v210, 16, v207
    v_and_b32 v207, 0xffff0000, v207
    v_mul_f32 v210, v210, v209
    s_add_u32 m0, s74, 8192
    v_mul_f32 v207, v207, v239
    v_cvt_pk_bf16_f32 v210, 0, v210
    buffer_load_dwordx4 v16, s[12:15], s71 offen lds
    v_cvt_pk_bf16_f32 v207, 0, v207
    v_add_f32 v243, v243, v210
    v_add_f32 v243, v243, v207
    buffer_load_dwordx4 v17, s[12:15], s71 offen offset:1024 lds
    buffer_load_dwordx2 v[236:237], v248, s[48:51], s70 offen
    s_add_u32 s70, s70, 128
    s_cmp_eq_u32 s70, 1280
    s_cselect_b32 s70, 0, s70
    s_waitcnt vmcnt(13)
    v_cmp_ne_u32 vcc, 1, v255
    s_nop 0
    s_or_b32 s92, vcc_lo, vcc_hi
    s_cbranch_scc0 L_ok_31
    s_mov_b32 s90, 0
L_poll_32:
    buffer_load_dword v255, v254, s[28:31], 0 offen sc1
    s_waitcnt vmcnt(0)
    v_cmp_ne_u32 vcc, 1, v255
    s_nop 0
    s_or_b32 s92, vcc_lo, vcc_hi
    s_cbranch_scc0 L_pdone_33
    s_sleep 4
    s_add_u32 s90, s90, 1
    s_cmp_lt_u32 s90, 40000
    s_cbranch_scc1 L_poll_32
L_pdone_33:
L_ok_31:
    s_barrier
    ds_read_b64 v[204:205], v202 offset:0
    ds_read_b64 v[206:207], v203 offset:0
    s_add_u32 m0, s73, 49152
    s_mul_i32 s71, s70, 1728
    v_lshlrev_b32 v208, 16, v240
    v_and_b32 v240, 0xffff0000, v240
    buffer_load_dwordx4 v8, s[4:7], s70 offen offset:0 lds
    v_lshlrev_b32 v209, 16, v241
    v_and_b32 v241, 0xffff0000, v241
    buffer_load_dwordx4 v9, s[4:7], s70 offen offset:1024 lds
    s_waitcnt lgkmcnt(0)
    v_lshlrev_b32 v210, 16, v204
    v_and_b32 v204, 0xffff0000, v204
    buffer_load_dwordx4 v10, s[4:7], s70 offen offset:2048 lds
    v_mul_f32 v210, v210, v208
    v_mul_f32 v204, v204, v240
    buffer_load_dwordx4 v11, s[4:7], s70 offen offset:3072 lds
    v_cvt_pk_bf16_f32 v210, 0, v210
    v_cvt_pk_bf16_f32 v204, 0, v204
    v_add_f32 v242, v242, v210
    s_add_u32 m0, s73, 53248
    v_add_f32 v242, v242, v204
    v_lshlrev_b32 v210, 16, v205
    buffer_load_dwordx4 v12, s[4:7], s70 offen offset:0 lds
    v_and_b32 v205, 0xffff0000, v205
    v_mul_f32 v210, v210, v209
    v_mul_f32 v205, v205, v241
    buffer_load_dwordx4 v13, s[4:7], s70 offen offset:1024 lds
    v_cvt_pk_bf16_f32 v210, 0, v210
    v_cvt_pk_bf16_f32 v205, 0, v205
    buffer_load_dwordx4 v14, s[4:7], s70 offen offset:2048 lds
    v_add_f32 v242, v242, v210
    v_add_f32 v242, v242, v205
    v_lshlrev_b32 v210, 16, v206
    buffer_load_dwordx4 v15, s[4:7], s70 offen offset:3072 lds
    v_and_b32 v206, 0xffff0000, v206
    v_mul_f32 v210, v210, v208
    s_add_u32 m0, s74, 49152
    v_mul_f32 v206, v206, v240
    v_cvt_pk_bf16_f32 v210, 0, v210
    v_cvt_pk_bf16_f32 v206, 0, v206
    buffer_load_dwordx4 v16, s[8:11], s71 offen lds
    v_add_f32 v243, v243, v210
    v_add_f32 v243, v243, v206
    buffer_load_dwordx4 v17, s[8:11], s71 offen offset:1024 lds
    v_lshlrev_b32 v210, 16, v207
    v_and_b32 v207, 0xffff0000, v207
    v_mul_f32 v210, v210, v209
    s_add_u32 m0, s74, 57344
    v_mul_f32 v207, v207, v241
    v_cvt_pk_bf16_f32 v210, 0, v210
    buffer_load_dwordx4 v16, s[12:15], s71 offen lds
    v_cvt_pk_bf16_f32 v207, 0, v207
    v_add_f32 v243, v243, v210
    v_add_f32 v243, v243, v207
    buffer_load_dwordx4 v17, s[12:15], s71 offen offset:1024 lds
    buffer_load_dwordx2 v[238:239], v248, s[48:51], s70 offen
    s_add_u32 s70, s70, 128
    s_cmp_eq_u32 s70, 1280
    s_cselect_b32 s70, 0, s70
    s_waitcnt vmcnt(13)
    s_barrier
    ds_read_b64 v[204:205], v200 offset:0
    ds_read_b64 v[206:207], v201 offset:0
    s_add_u32 m0, s73, 98304
    s_mul_i32 s71, s70, 1728
    v_lshlrev_b32 v208, 16, v236
    v_and_b32 v236, 0xffff0000, v236
    buffer_load_dwordx4 v8, s[4:7], s70 offen offset:0 lds
    v_lshlrev_b32 v209, 16, v237
    v_and_b32 v237, 0xffff0000, v237
    buffer_load_dwordx4 v9, s[4:7], s70 offen offset:1024 lds
    s_waitcnt lgkmcnt(0)
    v_lshlrev_b32 v210, 16, v204
    v_and_b32 v204, 0xffff0000, v204
    buffer_load_dwordx4 v10, s[4:7], s70 offen offset:2048 lds
    v_mul_f32 v210, v210, v208
    v_mul_f32 v204, v204, v236
    buffer_load_dwordx4 v11, s[4:7], s70 offen offset:3072 lds
    v_cvt_pk_bf16_f32 v210, 0, v210
    v_cvt_pk_bf16_f32 v204, 0, v204
    v_add_f32 v242, v242, v210
    s_add_u32 m0, s73, 102400
    v_add_f32 v242, v242, v204
    v_lshlrev_b32 v210, 16, v205
    buffer_load_dwordx4 v12, s[4:7], s70 offen offset:0 lds
    v_and_b32 v205, 0xffff0000, v205
    v_mul_f32 v210, v210, v209
    v_mul_f32 v205, v205, v237
    buffer_load_dwordx4 v13, s[4:7], s70 offen offset:1024 lds
    v_cvt_pk_bf16_f32 v210, 0, v210
    v_cvt_pk_bf16_f32 v205, 0, v205
    buffer_load_dwordx4 v14, s[4:7], s70 offen offset:2048 lds
    v_add_f32 v242, v242, v210
    v_add_f32 v242, v242, v205
    v_lshlrev_b32 v210, 16, v206
    buffer_load_dwordx4 v15, s[4:7], s70 offen offset:3072 lds
    v_and_b32 v206, 0xffff0000, v206
    v_mul_f32 v210, v210, v208
    s_add_u32 m0, s74, 98304
    v_mul_f32 v206, v206, v236
    v_cvt_pk_bf16_f32 v210, 0, v210
    v_cvt_pk_bf16_f32 v206, 0, v206
    buffer_load_dwordx4 v16, s[8:11], s71 offen lds
    v_add_f32 v243, v243, v210
    v_add_f32 v243, v243, v206
    buffer_load_dwordx4 v17, s[8:11], s71 offen offset:1024 lds
    v_lshlrev_b32 v210, 16, v207
    v_and_b32 v207, 0xffff0000, v207
    v_mul_f32 v210, v210, v209
    s_add_u32 m0, s74, 106496
    v_mul_f32 v207, v207, v237
    v_cvt_pk_bf16_f32 v210, 0, v210
    buffer_load_dwordx4 v16, s[12:15], s71 offen lds
    v_cvt_pk_bf16_f32 v207, 0, v207
    v_add_f32 v243, v243, v210
    v_add_f32 v243, v243, v207
    buffer_load_dwordx4 v17, s[12:15], s71 offen offset:1024 lds
    buffer_load_dwordx2 v[240:241], v248, s[48:51], s70 offen
    s_add_u32 s70, s70, 128
    s_cmp_eq_u32 s70, 1280
    s_cselect_b32 s70, 0, s70
    s_waitcnt vmcnt(13)
    s_barrier
    ds_read_b64 v[204:205], v200 offset:49152
    ds_read_b64 v[206:207], v201 offset:49152
    s_add_u32 m0, s73, 0
    s_mul_i32 s71, s70, 1728
    v_lshlrev_b32 v208, 16, v238
    v_and_b32 v238, 0xffff0000, v238
    buffer_load_dwordx4 v8, s[4:7], s70 offen offset:0 lds
    v_lshlrev_b32 v209, 16, v239
    v_and_b32 v239, 0xffff0000, v239
    buffer_load_dwordx4 v9, s[4:7], s70 offen offset:1024 lds
    s_waitcnt lgkmcnt(0)
    v_lshlrev_b32 v210, 16, v204
    v_and_b32 v204, 0xffff0000, v204
    buffer_load_dwordx4 v10, s[4:7], s70 offen offset:2048 lds
    v_mul_f32 v210, v210, v208
    v_mul_f32 v204, v204, v238
    buffer_load_dwordx4 v11, s[4:7], s70 offen offset:3072 lds
    v_cvt_pk_bf16_f32 v210, 0, v210
    v_cvt_pk_bf16_f32 v204, 0, v204
    v_add_f32 v242, v242, v210
    s_add_u32 m0, s73, 4096
    v_add_f32 v242, v242, v204
    v_lshlrev_b32 v210, 16, v205
    buffer_load_dwordx4 v12, s[4:7], s70 offen offset:0 lds
    v_and_b32 v205, 0xffff0000, v205
    v_mul_f32 v210, v210, v209
    v_mul_f32 v205, v205, v239
    buffer_load_dwordx4 v13, s[4:7], s70 offen offset:1024 lds
    v_cvt_pk_bf16_f32 v210, 0, v210
    v_cvt_pk_bf16_f32 v205, 0, v205
    buffer_load_dwordx4 v14, s[4:7], s70 offen offset:2048 lds
    v_add_f32 v242, v242, v210
    v_add_f32 v242, v242, v205
    v_lshlrev_b32 v210, 16, v206
    buffer_load_dwordx4 v15, s[4:7], s70 offen offset:3072 lds
    v_and_b32 v206, 0xffff0000, v206
    v_mul_f32 v210, v210, v208
    s_add_u32 m0, s74, 0
    v_mul_f32 v206, v206, v238
    v_cvt_pk_bf16_f32 v210, 0, v210
    v_cvt_pk_bf16_f32 v206, 0, v206
    buffer_load_dwordx4 v16, s[8:11], s71 offen lds
    v_add_f32 v243, v243, v210
    v_add_f32 v243, v243, v206
    buffer_load_dwordx4 v17, s[8:11], s71 offen offset:1024 lds
    v_lshlrev_b32 v210, 16, v207
    v_and_b32 v207, 0xffff0000, v207
    v_mul_f32 v210, v210, v209
    s_add_u32 m0, s74, 8192
    v_mul_f32 v207, v207, v239
    v_cvt_pk_bf16_f32 v210, 0, v210
    buffer_load_dwordx4 v16, s[12:15], s71 offen lds
    v_cvt_pk_bf16_f32 v207, 0, v207
    v_add_f32 v243, v243, v210
    v_add_f32 v243, v243, v207
    buffer_load_dwordx4 v17, s[12:15], s71 offen offset:1024 lds
    buffer_load_dwordx2 v[236:237], v248, s[48:51], s70 offen
    s_add_u32 s70, s70, 128
    s_cmp_eq_u32 s70, 1280
    s_cselect_b32 s70, 0, s70
    s_waitcnt vmcnt(13)
    s_barrier
    ds_read_b64 v[204:205], v202 offset:0
    ds_read_b64 v[206:207], v203 offset:0
    s_add_u32 m0, s73, 49152
    s_mul_i32 s71, s70, 1728
    v_lshlrev_b32 v208, 16, v240
    v_and_b32 v240, 0xffff0000, v240
    buffer_load_dwordx4 v8, s[4:7], s70 offen offset:0 lds
    v_lshlrev_b32 v209, 16, v241
    v_and_b32 v241, 0xffff0000, v241
    buffer_load_dwordx4 v9, s[4:7], s70 offen offset:1024 lds
    s_waitcnt lgkmcnt(0)
    v_lshlrev_b32 v210, 16, v204
    v_and_b32 v204, 0xffff0000, v204
    buffer_load_dwordx4 v10, s[4:7], s70 offen offset:2048 lds
    v_mul_f32 v210, v210, v208
    v_mul_f32 v204, v204, v240
    buffer_load_dwordx4 v11, s[4:7], s70 offen offset:3072 lds
    v_cvt_pk_bf16_f32 v210, 0, v210
    v_cvt_pk_bf16_f32 v204, 0, v204
    v_add_f32 v242, v242, v210
    s_add_u32 m0, s73, 53248
    v_add_f32 v242, v242, v204
    v_lshlrev_b32 v210, 16, v205
    buffer_load_dwordx4 v12, s[4:7], s70 offen offset:0 lds
    v_and_b32 v205, 0xffff0000, v205
    v_mul_f32 v210, v210, v209
    v_mul_f32 v205, v205, v241
    buffer_load_dwordx4 v13, s[4:7], s70 offen offset:1024 lds
    v_cvt_pk_bf16_f32 v210, 0, v210
    v_cvt_pk_bf16_f32 v205, 0, v205
    buffer_load_dwordx4 v14, s[4:7], s70 offen offset:2048 lds
    v_add_f32 v242, v242, v210
    v_add_f32 v242, v242, v205
    v_lshlrev_b32 v210, 16, v206
    buffer_load_dwordx4 v15, s[4:7], s70 offen offset:3072 lds
    v_and_b32 v206, 0xffff0000, v206
    v_mul_f32 v210, v210, v208
    s_add_u32 m0, s74, 49152
    v_mul_f32 v206, v206, v240
    v_cvt_pk_bf16_f32 v210, 0, v210
    v_cvt_pk_bf16_f32 v206, 0, v206
    buffer_load_dwordx4 v16, s[8:11], s71 offen lds
    v_add_f32 v243, v243, v210
    v_add_f32 v243, v243, v206
    buffer_load_dwordx4 v17, s[8:11], s71 offen offset:1024 lds
    v_lshlrev_b32 v210, 16, v207
    v_and_b32 v207, 0xffff0000, v207
    v_mul_f32 v210, v210, v209
    s_add_u32 m0, s74, 57344
    v_mul_f32 v207, v207, v241
    v_cvt_pk_bf16_f32 v210, 0, v210
    buffer_load_dwordx4 v16, s[12:15], s71 offen lds
    v_cvt_pk_bf16_f32 v207, 0, v207
    v_add_f32 v243, v243, v210
    v_add_f32 v243, v243, v207
    buffer_load_dwordx4 v17, s[12:15], s71 offen offset:1024 lds
    buffer_load_dwordx2 v[238:239], v248, s[48:51], s70 offen
    s_add_u32 s70, s70, 128
    s_cmp_eq_u32 s70, 1280
    s_cselect_b32 s70, 0, s70
    s_waitcnt vmcnt(13)
    s_barrier
    ds_read_b64 v[204:205], v200 offset:0
    ds_read_b64 v[206:207], v201 offset:0
    s_add_u32 m0, s73, 98304
    s_mul_i32 s71, s70, 1728
    v_lshlrev_b32 v208, 16, v236
    v_and_b32 v236, 0xffff0000, v236
    buffer_load_dwordx4 v8, s[4:7], s70 offen offset:0 lds
    v_lshlrev_b32 v209, 16, v237
    v_and_b32 v237, 0xffff0000, v237
    buffer_load_dwordx4 v9, s[4:7], s70 offen offset:1024 lds
    s_waitcnt lgkmcnt(0)
    v_lshlrev_b32 v210, 16, v204
    v_and_b32 v204, 0xffff0000, v204
    buffer_load_dwordx4 v10, s[4:7], s70 offen offset:2048 lds
    v_mul_f32 v210, v210, v208
    v_mul_f32 v204, v204, v236
    buffer_load_dwordx4 v11, s[4:7], s70 offen offset:3072 lds
    v_cvt_pk_bf16_f32 v210, 0, v210
    v_cvt_pk_bf16_f32 v204, 0, v204
    v_add_f32 v242, v242, v210
    s_add_u32 m0, s73, 102400
    v_add_f32 v242, v242, v204
    v_lshlrev_b32 v210, 16, v205
    buffer_load_dwordx4 v12, s[4:7], s70 offen offset:0 lds
    v_and_b32 v205, 0xffff0000, v205
    v_mul_f32 v210, v210, v209
    v_mul_f32 v205, v205, v237
    buffer_load_dwordx4 v13, s[4:7], s70 offen offset:1024 lds
    v_cvt_pk_bf16_f32 v210, 0, v210
    v_cvt_pk_bf16_f32 v205, 0, v205
    buffer_load_dwordx4 v14, s[4:7], s70 offen offset:2048 lds
    v_add_f32 v242, v242, v210
    v_add_f32 v242, v242, v205
    v_lshlrev_b32 v210, 16, v206
    buffer_load_dwordx4 v15, s[4:7], s70 offen offset:3072 lds
    v_and_b32 v206, 0xffff0000, v206
    v_mul_f32 v210, v210, v208
    s_add_u32 m0, s74, 98304
    v_mul_f32 v206, v206, v236
    v_cvt_pk_bf16_f32 v210, 0, v210
    v_cvt_pk_bf16_f32 v206, 0, v206
    buffer_load_dwordx4 v16, s[8:11], s71 offen lds
    v_add_f32 v243, v243, v210
    v_add_f32 v243, v243, v206
    buffer_load_dwordx4 v17, s[8:11], s71 offen offset:1024 lds
    v_lshlrev_b32 v210, 16, v207
    v_and_b32 v207, 0xffff0000, v207
    v_mul_f32 v210, v210, v209
    s_add_u32 m0, s74, 106496
    v_mul_f32 v207, v207, v237
    v_cvt_pk_bf16_f32 v210, 0, v210
    buffer_load_dwordx4 v16, s[12:15], s71 offen lds
    v_cvt_pk_bf16_f32 v207, 0, v207
    v_add_f32 v243, v243, v210
    v_add_f32 v243, v243, v207
    buffer_load_dwordx4 v17, s[12:15], s71 offen offset:1024 lds
    buffer_load_dwordx2 v[240:241], v248, s[48:51], s70 offen
    s_add_u32 s70, s70, 128
    s_cmp_eq_u32 s70, 1280
    s_cselect_b32 s70, 0, s70
    s_waitcnt vmcnt(13)
    s_barrier
    ds_read_b64 v[204:205], v200 offset:49152
    ds_read_b64 v[206:207], v201 offset:49152
    buffer_load_dword v219, v218, s[16:19], 0 offen sc1
    buffer_load_dword v220, v218, s[16:19], 0 offen offset:256 sc1
    s_add_u32 m0, s73, 0
    s_mul_i32 s71, s70, 1728
    v_lshlrev_b32 v208, 16, v238
    v_and_b32 v238, 0xffff0000, v238
    buffer_load_dwordx4 v8, s[4:7], s70 offen offset:0 lds
    v_lshlrev_b32 v209, 16, v239
    v_and_b32 v239, 0xffff0000, v239
    buffer_load_dwordx4 v9, s[4:7], s70 offen offset:1024 lds
    s_waitcnt lgkmcnt(0)
    v_lshlrev_b32 v210, 16, v204
    v_and_b32 v204, 0xffff0000, v204
    buffer_load_dwordx4 v10, s[4:7], s70 offen offset:2048 lds
    v_mul_f32 v210, v210, v208
    v_mul_f32 v204, v204, v238
    buffer_load_dwordx4 v11, s[4:7], s70 offen offset:3072 lds
    v_cvt_pk_bf16_f32 v210, 0, v210
    v_cvt_pk_bf16_f32 v204, 0, v204
    v_add_f32 v242, v242, v210
    s_add_u32 m0, s73, 4096
    v_add_f32 v242, v242, v204
    v_lshlrev_b32 v210, 16, v205
    buffer_load_dwordx4 v12, s[4:7], s70 offen offset:0 lds
    v_and_b32 v205, 0xffff0000, v205
    v_mul_f32 v210, v210, v209
    v_mul_f32 v205, v205, v239
    buffer_load_dwordx4 v13, s[4:7], s70 offen offset:1024 lds
    v_cvt_pk_bf16_f32 v210, 0, v210
    v_cvt_pk_bf16_f32 v205, 0, v205
    buffer_load_dwordx4 v14, s[4:7], s70 offen offset:2048 lds
    v_add_f32 v242, v242, v210
    v_add_f32 v242, v242, v205
    v_lshlrev_b32 v210, 16, v206
    buffer_load_dwordx4 v15, s[4:7], s70 offen offset:3072 lds
    v_and_b32 v206, 0xffff0000, v206
    v_mul_f32 v210, v210, v208
    s_add_u32 m0, s74, 0
    v_mul_f32 v206, v206, v238
    v_cvt_pk_bf16_f32 v210, 0, v210
    v_cvt_pk_bf16_f32 v206, 0, v206
    buffer_load_dwordx4 v16, s[8:11], s71 offen lds
    v_add_f32 v243, v243, v210
    v_add_f32 v243, v243, v206
    buffer_load_dwordx4 v17, s[8:11], s71 offen offset:1024 lds
    v_lshlrev_b32 v210, 16, v207
    v_and_b32 v207, 0xffff0000, v207
    v_mul_f32 v210, v210, v209
    s_add_u32 m0, s74, 8192
    v_mul_f32 v207, v207, v239
    v_cvt_pk_bf16_f32 v210, 0, v210
    buffer_load_dwordx4 v16, s[12:15], s71 offen lds
    v_cvt_pk_bf16_f32 v207, 0, v207
    v_add_f32 v243, v243, v210
    v_add_f32 v243, v243, v207
    buffer_load_dwordx4 v17, s[12:15], s71 offen offset:1024 lds
    buffer_load_dwordx2 v[236:237], v248, s[48:51], s70 offen
    v_add_u32 v16, 4096, v1
    s_waitcnt vmcnt(15)
    s_barrier
    ds_read_b64 v[204:205], v202 offset:0
    ds_read_b64 v[206:207], v203 offset:0
    s_waitcnt vmcnt(13)
    v_and_b32 v219, v219, v220
    v_cmp_ne_u32 vcc, 1, v219
    s_nop 0
    s_or_b32 s92, vcc_lo, vcc_hi
    s_cbranch_scc0 L_ok_34
    s_mov_b32 s90, 0
L_poll_35:
    buffer_load_dword v219, v218, s[16:19], 0 offen sc1
    buffer_load_dword v220, v218, s[16:19], 0 offen offset:256 sc1
    s_waitcnt vmcnt(0)
    v_and_b32 v219, v219, v220
    v_cmp_ne_u32 vcc, 1, v219
    s_nop 0
    s_or_b32 s92, vcc_lo, vcc_hi
    s_cbranch_scc0 L_pdone_36
    s_sleep 4
    s_add_u32 s90, s90, 1
    s_cmp_lt_u32 s90, 40000
    s_cbranch_scc1 L_poll_35
L_pdone_36:
L_ok_34:
    s_add_u32 s87, s65, 102400
    buffer_load_dwordx4 v[36:39], v1, s[16:19], s87 offen offset:0 sc1
    v_lshlrev_b32 v208, 16, v240
    v_and_b32 v240, 0xffff0000, v240
    v_lshlrev_b32 v209, 16, v241
    v_and_b32 v241, 0xffff0000, v241
    buffer_load_dwordx4 v[40:43], v1, s[16:19], s87 offen offset:1024 sc1
    s_waitcnt lgkmcnt(0)
    v_lshlrev_b32 v210, 16, v204
    v_and_b32 v204, 0xffff0000, v204
    v_mul_f32 v210, v210, v208
    v_mul_f32 v204, v204, v240
    buffer_load_dwordx4 v[44:47], v1, s[16:19], s87 offen offset:2048 sc1
    v_cvt_pk_bf16_f32 v210, 0, v210
    v_cvt_pk_bf16_f32 v204, 0, v204
    v_add_f32 v242, v242, v210
    v_add_f32 v242, v242, v204
    v_lshlrev_b32 v210, 16, v205
    buffer_load_dwordx4 v[48:51], v1, s[16:19], s87 offen offset:3072 sc1
    v_and_b32 v205, 0xffff0000, v205
    v_mul_f32 v210, v210, v209
    v_mul_f32 v205, v205, v241
    v_cvt_pk_bf16_f32 v210, 0, v210
    buffer_load_dwordx4 v[52:55], v16, s[16:19], s87 offen offset:0 sc1
    v_cvt_pk_bf16_f32 v205, 0, v205
    v_add_f32 v242, v242, v210
    v_add_f32 v242, v242, v205
    v_lshlrev_b32 v210, 16, v206
    v_and_b32 v206, 0xffff0000, v206
    s_add_u32 s87, s66, 0
    buffer_load_dwordx4 v[56:59], v1, s[16:19], s87 offen offset:0 sc1
    v_mul_f32 v210, v210, v208
    v_mul_f32 v206, v206, v240
    v_cvt_pk_bf16_f32 v210, 0, v210
    v_cvt_pk_bf16_f32 v206, 0, v206
    v_add_f32 v243, v243, v210
    buffer_load_dwordx4 v[60:63], v1, s[16:19], s87 offen offset:1024 sc1
    v_add_f32 v243, v243, v206
    v_lshlrev_b32 v210, 16, v207
    v_and_b32 v207, 0xffff0000, v207
    v_mul_f32 v210, v210, v209
    v_mul_f32 v207, v207, v241
    buffer_load_dwordx4 v[64:67], v1, s[16:19], s87 offen offset:2048 sc1
    v_cvt_pk_bf16_f32 v210, 0, v210
    v_cvt_pk_bf16_f32 v207, 0, v207
    v_add_f32 v243, v243, v210
    v_add_f32 v243, v243, v207
    s_waitcnt vmcnt(8)
    s_barrier
    ds_read_b64 v[204:205], v200 offset:0
    ds_read_b64 v[206:207], v201 offset:0
    s_add_u32 s87, s66, 0
    buffer_load_dwordx4 v[68:71], v1, s[16:19], s87 offen offset:3072 sc1
    v_lshlrev_b32 v208, 16, v236
    v_and_b32 v236, 0xffff0000, v236
    v_lshlrev_b32 v209, 16, v237
    v_and_b32 v237, 0xffff0000, v237
    s_waitcnt lgkmcnt(0)
    v_lshlrev_b32 v210, 16, v204
    v_and_b32 v204, 0xffff0000, v204
    v_mul_f32 v210, v210, v208
    v_mul_f32 v204, v204, v236
    v_cvt_pk_bf16_f32 v210, 0, v210
    v_cvt_pk_bf16_f32 v204, 0, v204
    buffer_load_dwordx4 v[72:75], v16, s[16:19], s87 offen offset:0 sc1
    v_add_f32 v242, v242, v210
    v_add_f32 v242, v242, v204
    v_lshlrev_b32 v210, 16, v205
    v_and_b32 v205, 0xffff0000, v205
    v_mul_f32 v210, v210, v209
    v_mul_f32 v205, v205, v237
    v_cvt_pk_bf16_f32 v210, 0, v210
    v_cvt_pk_bf16_f32 v205, 0, v205
    v_add_f32 v242, v242, v210
    v_add_f32 v242, v242, v205
    v_lshlrev_b32 v210, 16, v206
    v_and_b32 v206, 0xffff0000, v206
    s_add_u32 s87, s66, 102400
    buffer_load_dwordx4 v[76:79], v1, s[16:19], s87 offen offset:0 sc1
    v_mul_f32 v210, v210, v208
    v_mul_f32 v206, v206, v236
    v_cvt_pk_bf16_f32 v210, 0, v210
    v_cvt_pk_bf16_f32 v206, 0, v206
    v_add_f32 v243, v243, v210
    v_add_f32 v243, v243, v206
    v_lshlrev_b32 v210, 16, v207
    v_and_b32 v207, 0xffff0000, v207
    v_mul_f32 v210, v210, v209
    v_mul_f32 v207, v207, v237
    v_cvt_pk_bf16_f32 v210, 0, v210
    buffer_load_dwordx4 v[80:83], v1, s[16:19], s87 offen offset:1024 sc1
    v_cvt_pk_bf16_f32 v207, 0, v207
    v_add_f32 v243, v243, v210
    v_add_f32 v243, v243, v207
    v_add_f32_dpp v242, v242, v242 quad_perm:[1,0,3,2] row_mask:0xf bank_mask:0xf
    s_nop 0
    v_add_f32_dpp v243, v243, v243 quad_perm:[1,0,3,2] row_mask:0xf bank_mask:0xf
    v_add_f32_dpp v242, v242, v242 quad_perm:[2,3,0,1] row_mask:0xf bank_mask:0xf
    s_nop 0
    v_add_f32_dpp v243, v243, v243 quad_perm:[2,3,0,1] row_mask:0xf bank_mask:0xf
    v_add_f32_dpp v242, v242, v242 row_half_mirror row_mask:0xf bank_mask:0xf
    s_nop 0
    v_add_f32_dpp v243, v243, v243 row_half_mirror row_mask:0xf bank_mask:0xf
    v_add_f32_dpp v242, v242, v242 row_mirror row_mask:0xf bank_mask:0xf
    s_nop 0
    v_add_f32_dpp v243, v243, v243 row_mirror row_mask:0xf bank_mask:0xf
    v_and_b32 v3, 15, v2
    buffer_load_dwordx4 v[84:87], v1, s[16:19], s87 offen offset:2048 sc1
    v_cmp_eq_u32 vcc, 1, v3
    s_nop 1
    v_cndmask_b32 v242, v242, v243, vcc
    v_cvt_pk_bf16_f32 v242, 0, v242
    v_mul_f32 v242, 0xbfb8aa3b, v242
    v_exp_f32 v242, v242
    s_nop 0
    v_add_f32 v242, 1.0, v242
    v_rcp_f32 v242, v242
    s_nop 0
    v_cvt_pk_bf16_f32 v242, 0, v242
    v_sub_f32 v243, 1.0, v242
    v_cvt_pk_bf16_f32 v242, v242, v243
    v_lshrrev_b32 v4, 4, v2
    s_waitcnt vmcnt(12)
    buffer_load_dwordx4 v[88:91], v1, s[16:19], s87 offen offset:3072 sc1
    v_lshlrev_b32 v4, 2, v4
    v_lshl_add_u32 v4, v3, 4, v4
    v_cmp_gt_u32 vcc, 2, v3
    v_mov_b32 v3, 2146435072
    s_nop 0
    v_cndmask_b32 v3, v3, v4, vcc
    buffer_store_dword v242, v3, s[16:19], s78 offen sc1
    s_waitcnt vmcnt(12)
    buffer_load_dwordx4 v[92:95], v16, s[16:19], s87 offen offset:0 sc1
    s_add_u32 s87, s67, 0
    s_waitcnt vmcnt(12)
    buffer_load_dwordx4 v[96:99], v1, s[16:19], s87 offen offset:0 sc1
    s_waitcnt lgkmcnt(0)
    s_barrier
    s_mul_i32 s82, s56, 5120
    s_add_u32 s80, s64, 0
    s_add_u32 m0, s82, 0
    s_waitcnt vmcnt(12)
    buffer_load_dwordx4 v1, s[16:19], s80 offen offset:0 sc1 lds
    s_waitcnt vmcnt(12)
    buffer_load_dwordx4 v1, s[16:19], s80 offen offset:1024 sc1 lds
    s_waitcnt vmcnt(12)
    buffer_load_dwordx4 v1, s[16:19], s80 offen offset:2048 sc1 lds
    s_waitcnt vmcnt(12)
    buffer_load_dwordx4 v1, s[16:19], s80 offen offset:3072 sc1 lds
    s_add_u32 m0, s82, 4096
    s_waitcnt vmcnt(12)
    buffer_load_dwordx4 v16, s[16:19], s80 offen sc1 lds
    s_add_u32 s80, s64, 102400
    s_add_u32 m0, s82, 20480
    s_waitcnt vmcnt(12)
    buffer_load_dwordx4 v1, s[16:19], s80 offen offset:0 sc1 lds
    s_waitcnt vmcnt(12)
    buffer_load_dwordx4 v1, s[16:19], s80 offen offset:1024 sc1 lds
    s_waitcnt vmcnt(12)
    buffer_load_dwordx4 v1, s[16:19], s80 offen offset:2048 sc1 lds
    s_waitcnt vmcnt(12)
    buffer_load_dwordx4 v1, s[16:19], s80 offen offset:3072 sc1 lds
    s_add_u32 m0, s82, 24576
    s_waitcnt vmcnt(12)
    buffer_load_dwordx4 v16, s[16:19], s80 offen sc1 lds
    s_add_u32 s80, s65, 0
    s_add_u32 m0, s82, 40960
    s_waitcnt vmcnt(12)
    buffer_load_dwordx4 v1, s[16:19], s80 offen offset:0 sc1 lds
    s_waitcnt vmcnt(12)
    buffer_load_dwordx4 v1, s[16:19], s80 offen offset:1024 sc1 lds
    s_waitcnt vmcnt(12)
    buffer_load_dwordx4 v1, s[16:19], s80 offen offset:2048 sc1 lds
    s_waitcnt vmcnt(12)
    buffer_load_dwordx4 v1, s[16:19], s80 offen offset:3072 sc1 lds
    s_add_u32 m0, s82, 45056
    s_waitcnt vmcnt(12)
    buffer_load_dwordx4 v16, s[16:19], s80 offen sc1 lds
    s_add_u32 s87, s67, 0
    s_waitcnt vmcnt(12)
    buffer_load_dwordx4 v[100:103], v1, s[16:19], s87 offen offset:1024 sc1
    s_waitcnt vmcnt(12)
    buffer_load_dwordx4 v[104:107], v1, s[16:19], s87 offen offset:2048 sc1
    s_waitcnt vmcnt(12)
    buffer_load_dwordx4 v[108:111], v1, s[16:19], s87 offen offset:3072 sc1
    s_waitcnt vmcnt(12)
    buffer_load_dwordx4 v[112:115], v16, s[16:19], s87 offen offset:0 sc1
    s_add_u32 s87, s67, 102400
    s_waitcnt vmcnt(12)
    buffer_load_dwordx4 v[116:119], v1, s[16:19], s87 offen offset:0 sc1
    s_waitcnt vmcnt(12)
    buffer_load_dwordx4 v[120:123], v1, s[16:19], s87 offen offset:1024 sc1
    s_waitcnt vmcnt(12)
    buffer_load_dwordx4 v[124:127], v1, s[16:19], s87 offen offset:2048 sc1
    s_waitcnt vmcnt(12)
    buffer_load_dwordx4 v[128:131], v1, s[16:19], s87 offen offset:3072 sc1
    s_waitcnt vmcnt(12)
    buffer_load_dwordx4 v[132:135], v16, s[16:19], s87 offen offset:0 sc1
    s_add_u32 s87, s68, 0
    s_waitcnt vmcnt(12)
    buffer_load_dwordx4 v[136:139], v1, s[16:19], s87 offen offset:0 sc1
    s_waitcnt vmcnt(12)
    buffer_load_dwordx4 v[140:143], v1, s[16:19], s87 offen offset:1024 sc1
    s_waitcnt vmcnt(12)
    buffer_load_dwordx4 v[144:147], v1, s[16:19], s87 offen offset:2048 sc1
    s_waitcnt vmcnt(12)
    buffer_load_dwordx4 v[148:151], v1, s[16:19], s87 offen offset:3072 sc1
    s_waitcnt vmcnt(12)
    buffer_load_dwordx4 v[152:155], v16, s[16:19], s87 offen offset:0 sc1
    s_add_u32 s87, s68, 102400
    s_waitcnt vmcnt(12)
    buffer_load_dwordx4 v[156:159], v1, s[16:19], s87 offen offset:0 sc1
    s_waitcnt vmcnt(12)
    buffer_load_dwordx4 v[160:163], v1, s[16:19], s87 offen offset:1024 sc1
    s_waitcnt vmcnt(12)
    buffer_load_dwordx4 v[164:167], v1, s[16:19], s87 offen offset:2048 sc1
    s_waitcnt vmcnt(12)
    buffer_load_dwordx4 v[168:171], v1, s[16:19], s87 offen offset:3072 sc1
    s_waitcnt vmcnt(12)
    buffer_load_dwordx4 v[172:175], v16, s[16:19], s87 offen offset:0 sc1
    s_add_u32 s87, s69, 204800
    s_waitcnt vmcnt(12)
    buffer_load_dwordx4 v[176:179], v1, s[16:19], s87 offen offset:0 sc1
    s_waitcnt vmcnt(12)
    buffer_load_dwordx4 v[180:183], v1, s[16:19], s87 offen offset:1024 sc1
    s_waitcnt vmcnt(12)
    buffer_load_dwordx4 v[184:187], v1, s[16:19], s87 offen offset:2048 sc1
    s_waitcnt vmcnt(12)
    buffer_load_dwordx4 v[188:191], v1, s[16:19], s87 offen offset:3072 sc1
    s_waitcnt vmcnt(12)
    buffer_load_dwordx4 v[192:195], v16, s[16:19], s87 offen offset:0 sc1
    s_add_u32 s87, s69, 225280
    s_waitcnt vmcnt(12)
    buffer_load_dwordx4 v[196:199], v1, s[16:19], s87 offen offset:0 sc1
    s_waitcnt vmcnt(12)
    buffer_load_dwordx4 v[200:203], v1, s[16:19], s87 offen offset:1024 sc1
    s_waitcnt vmcnt(12)
    buffer_load_dwordx4 v[204:207], v1, s[16:19], s87 offen offset:2048 sc1
    s_waitcnt vmcnt(12)
    buffer_load_dwordx4 v[208:211], v1, s[16:19], s87 offen offset:3072 sc1
    s_waitcnt vmcnt(12)
    buffer_load_dwordx4 v[212:215], v16, s[16:19], s87 offen offset:0 sc1
L_help_g2:
    s_mul_i32 s80, s56, 5120
    v_add_u32 v8, s80, v1
    v_add_u32 v9, 61440, v8
    s_mul_i32 s80, s58, 320
    s_add_u32 s80, s80, 7680
    v_min_u32 v3, 19, v2
    v_lshlrev_b32 v3, 4, v3
    v_add_u32 v11, s80, v3
    v_lshrrev_b32 v3, 3, v2
    v_mul_u32_u24 v3, 4352, v3
    v_and_b32 v4, 7, v2
    v_lshl_add_u32 v10, v4, 4, v3
    s_mul_i32 s70, s58, 348160
    s_lshl_b32 s81, s57, 7
    s_add_u32 s70, s70, s81
    s_add_u32 s70, s70, 2686976
    s_barrier
    v_add_u32 v17, 122880, v8
    s_waitcnt vmcnt(40)
    ds_write_b128 v9, v[36:39] offset:0
    ds_write_b128 v9, v[40:43] offset:1024
    ds_write_b128 v9, v[44:47] offset:2048
    ds_write_b128 v9, v[48:51] offset:3072
    ds_write_b128 v9, v[52:55] offset:4096
    s_waitcnt vmcnt(35)
    ds_write_b128 v9, v[56:59] offset:20480
    ds_write_b128 v9, v[60:63] offset:21504
    ds_write_b128 v9, v[64:67] offset:22528
    ds_write_b128 v9, v[68:71] offset:23552
    ds_write_b128 v9, v[72:75] offset:24576
    s_waitcnt vmcnt(30)
    ds_write_b128 v9, v[76:79] offset:40960
    ds_write_b128 v9, v[80:83] offset:41984
    ds_write_b128 v9, v[84:87] offset:43008
    ds_write_b128 v9, v[88:91] offset:44032
    ds_write_b128 v9, v[92:95] offset:45056
    s_waitcnt vmcnt(25)
    ds_write_b128 v17, v[96:99] offset:0
    ds_write_b128 v17, v[100:103] offset:1024
    ds_write_b128 v17, v[104:107] offset:2048
    ds_write_b128 v17, v[108:111] offset:3072
    ds_write_b128 v17, v[112:115] offset:4096
    s_waitcnt vmcnt(20)
    ds_write_b128 v17, v[116:119] offset:20480
    ds_write_b128 v17, v[120:123] offset:21504
    ds_write_b128 v17, v[124:127] offset:22528
    ds_write_b128 v17, v[128:131] offset:23552
    ds_write_b128 v17, v[132:135] offset:24576
    s_waitcnt lgkmcnt(0)
    s_barrier
    s_add_u32 s87, s69, 245760
    s_waitcnt vmcnt(8)
    buffer_load_dwordx4 v[216:219], v1, s[16:19], s87 offen offset:0 sc1
    ds_write_b128 v8, v[136:139] offset:0
    s_waitcnt vmcnt(8)
    buffer_load_dwordx4 v[220:223], v1, s[16:19], s87 offen offset:1024 sc1
    ds_write_b128 v8, v[140:143] offset:1024
    ds_write_b128 v8, v[144:147] offset:2048
    s_waitcnt vmcnt(8)
    buffer_load_dwordx4 v[224:227], v1, s[16:19], s87 offen offset:2048 sc1
    ds_write_b128 v8, v[148:151] offset:3072
    ds_write_b128 v8, v[152:155] offset:4096
    s_waitcnt vmcnt(8)
    buffer_load_dwordx4 v[228:231], v1, s[16:19], s87 offen offset:3072 sc1
    ds_write_b128 v8, v[156:159] offset:20480
    s_waitcnt vmcnt(8)
    buffer_load_dwordx4 v[232:235], v16, s[16:19], s87 offen offset:0 sc1
    ds_write_b128 v8, v[160:163] offset:21504
    ds_write_b128 v8, v[164:167] offset:22528
    s_lshr_b32 s87, s56, 1
    s_mul_i32 s87, s87, 10240
    s_sub_u32 s87, s69, s87
    s_add_u32 s87, s87, 266240
    s_waitcnt vmcnt(8)
    buffer_load_dwordx4 v[236:239], v1, s[16:19], s87 offen offset:0 sc1
    ds_write_b128 v8, v[168:171] offset:23552
    ds_write_b128 v8, v[172:175] offset:24576
    s_waitcnt vmcnt(8)
    buffer_load_dwordx4 v[240:243], v1, s[16:19], s87 offen offset:1024 sc1
    ds_write_b128 v8, v[176:179] offset:40960
    s_waitcnt vmcnt(8)
    buffer_load_dwordx4 v[244:247], v1, s[16:19], s87 offen offset:2048 sc1
    ds_write_b128 v8, v[180:183] offset:41984
    ds_write_b128 v8, v[184:187] offset:43008
    s_waitcnt vmcnt(8)
    buffer_load_dwordx4 v[248:251], v1, s[16:19], s87 offen offset:3072 sc1
    ds_write_b128 v8, v[188:191] offset:44032
    ds_write_b128 v8, v[192:195] offset:45056
    s_waitcnt vmcnt(8)
    buffer_load_dwordx4 v[252:255], v16, s[16:19], s87 offen offset:0 sc1
    s_waitcnt lgkmcnt(0)
    s_barrier
    ds_write_b128 v9, v[196:199] offset:0
    ds_write_b128 v9, v[200:203] offset:1024
    ds_write_b128 v9, v[204:207] offset:2048
    ds_write_b128 v9, v[208:211] offset:3072
    ds_write_b128 v9, v[212:215] offset:4096
    buffer_load_dwordx4 v[12:15], v11, s[16:19], 0 offen sc1
    s_waitcnt vmcnt(6)
    ds_write_b128 v9, v[216:219] offset:20480
    ds_write_b128 v9, v[220:223] offset:21504
    ds_write_b128 v9, v[224:227] offset:22528
    ds_write_b128 v9, v[228:231] offset:23552
    ds_write_b128 v9, v[232:235] offset:24576
    s_waitcnt vmcnt(1)
    s_cmp_ge_u32 s56, 2
    s_cbranch_scc1 L_no13
    ds_write_b128 v9, v[236:239] offset:40960
    ds_write_b128 v9, v[240:243] offset:41984
    ds_write_b128 v9, v[244:247] offset:43008
    ds_write_b128 v9, v[248:251] offset:44032
    ds_write_b128 v9, v[252:255] offset:45056
L_no13:
    s_waitcnt lgkmcnt(0)
    s_waitcnt vmcnt(0)
    v_and_b32 v12, v12, v13
    v_and_b32 v14, v14, v15
    v_and_b32 v12, v12, v14
    v_cmp_ne_u32 vcc, 1, v12
    s_nop 0
    s_or_b32 s92, vcc_lo, vcc_hi
    s_cselect_b32 s71, 1, 0
    s_cbranch_scc1 L_at_late
    s_add_u32 s81, s56, 0
    s_min_u32 s81, s81, 9
    s_lshl_b32 s82, s81, 10
    s_add_u32 m0, s82, 112640
    s_mul_i32 s81, s81, 34816
    s_add_u32 s81, s81, s70
    buffer_load_dwordx4 v10, s[16:19], s81 offen sc1 lds
    s_add_u32 s81, s56, 4
    s_min_u32 s81, s81, 9
    s_lshl_b32 s82, s81, 10
    s_add_u32 m0, s82, 112640
    s_mul_i32 s81, s81, 34816
    s_add_u32 s81, s81, s70
    buffer_load_dwordx4 v10, s[16:19], s81 offen sc1 lds
    s_add_u32 s81, s56, 8
    s_min_u32 s81, s81, 9
    s_lshl_b32 s82, s81, 10
    s_add_u32 m0, s82, 112640
    s_mul_i32 s81, s81, 34816
    s_add_u32 s81, s81, s70
    buffer_load_dwordx4 v10, s[16:19], s81 offen sc1 lds
L_at_late:
    s_barrier
    s_cmp_eq_u32 s71, 0
    s_cbranch_scc1 L_at_done
    s_mov_b32 s90, 0
L_poll_37:
    buffer_load_dwordx4 v[12:15], v11, s[16:19], 0 offen sc1
    s_waitcnt vmcnt(0)
    v_and_b32 v12, v12, v13
    v_and_b32 v14, v14, v15
    v_and_b32 v12, v12, v14
    v_cmp_ne_u32 vcc, 1, v12
    s_nop 0
    s_or_b32 s92, vcc_lo, vcc_hi
    s_cbranch_scc0 L_pdone_38
    s_sleep 4
    s_add_u32 s90, s90, 1
    s_cmp_lt_u32 s90, 40000
    s_cbranch_scc1 L_poll_37
L_pdone_38:
    s_add_u32 s81, s56, 0
    s_min_u32 s81, s81, 9
    s_lshl_b32 s82, s81, 10
    s_add_u32 m0, s82, 112640
    s_mul_i32 s81, s81, 34816
    s_add_u32 s81, s81, s70
    buffer_load_dwordx4 v10, s[16:19], s81 offen sc1 lds
    s_add_u32 s81, s56, 4
    s_min_u32 s81, s81, 9
    s_lshl_b32 s82, s81, 10
    s_add_u32 m0, s82, 112640
    s_mul_i32 s81, s81, 34816
    s_add_u32 s81, s81, s70
    buffer_load_dwordx4 v10, s[16:19], s81 offen sc1 lds
    s_add_u32 s81, s56, 8
    s_min_u32 s81, s81, 9
    s_lshl_b32 s82, s81, 10
    s_add_u32 m0, s82, 112640
    s_mul_i32 s81, s81, 34816
    s_add_u32 s81, s81, s70
    buffer_load_dwordx4 v10, s[16:19], s81 offen sc1 lds
L_at_done:
    s_waitcnt vmcnt(0)
    s_barrier
L_fin:
L_end:
    s_endpgm
.section .rodata,"a"
.p2align 6
.amdhsa_kernel gated_mix__ssm_conv_s4__glu_gated_bilinear__prompt_kernel
  .amdhsa_next_free_vgpr 256
  .amdhsa_next_free_sgpr 102
  .amdhsa_accum_offset 256
  .amdhsa_group_segment_fixed_size 0
  .amdhsa_kernarg_size 136
  .amdhsa_user_sgpr_count 2
  .amdhsa_user_sgpr_kernarg_segment_ptr 1
  .amdhsa_system_sgpr_workgroup_id_x 1
.end_amdhsa_kernel
```
